```python
import torch

def _softmax(x, axis=-1):
    return torch.softmax(x, dim=axis)
def _gelu(x):
    return torch.nn.functional.gelu(x, approximate="tanh")
def _silu(x):
    return torch.nn.functional.silu(x)
def _sigmoid(x):
    return torch.sigmoid(x)
def _layernorm(x, axis=-1, eps=1e-5):
    m = x.mean(dim=axis, keepdim=True)
    v = x.var(dim=axis, keepdim=True, unbiased=False)
    return (x - m) / torch.sqrt(v + eps)
def _scatter_add(tgt, idx, src, axis=0):
    return tgt.clone().index_add_(axis, idx, src)
def _segment_sum(src, seg, n):
    out = torch.zeros((n,) + src.shape[1:], dtype=src.dtype)
    return out.index_add_(0, seg, src)
def _pad(x, pw):
    flat = tuple(v for pair in reversed(pw) for v in pair)
    return torch.nn.functional.pad(x, flat)

kernel_name = 'standalone__gqa_softmax__near_ridge'

def setup_inputs():

    _w = (lambda a: (lambda t: t.to(torch.bfloat16) if t.is_floating_point() else t)(torch.as_tensor(a)))
    B, Hq, Hkv, Sq, Sk, D = 16, 32, 32, 512, 512, 192
    return {
        "q": _w((lambda *s: torch.randn(*s, dtype=torch.bfloat16) * 0.8)(B, Hq, Sq, D)),
        "k": _w((lambda *s: torch.randn(*s, dtype=torch.bfloat16) * 0.8)(B, Hkv, Sk, D)),
        "v": _w((lambda *s: torch.randn(*s, dtype=torch.bfloat16) * 0.05)(B, Hkv, Sk, D)),
    }

def reference(q, k, v):
    B, Hq, Sq, D = q.shape
    Hkv = k.shape[1]
    rep = Hq // Hkv
    k = (lambda x, n, axis: torch.repeat_interleave(x, n, dim=axis))(k, rep, axis=1)
    v = (lambda x, n, axis: torch.repeat_interleave(x, n, dim=axis))(v, rep, axis=1)
    scale = D ** -0.5
    scores = torch.einsum("bhqd,bhkd->bhqk", q, k) * scale
    p = _softmax(scores, axis=-1)
    return torch.einsum("bhqk,bhkd->bhqd", p, v)
```

```asm
; @launch grid=(256,1,1) block=(256,1,1) lds=147456
.amdgcn_target "amdgcn-amd-amdhsa--gfx950"
.text
.globl standalone__gqa_softmax__near_ridge_kernel
.p2align 8
.type standalone__gqa_softmax__near_ridge_kernel,@function
standalone__gqa_softmax__near_ridge_kernel:
    s_cmp_ge_u32 s2, 256
    s_cbranch_scc1 L_end
    s_load_dwordx4 s[4:7], s[0:1], 0
    s_load_dwordx4 s[8:11], s[0:1], 16
    v_and_b32 v1, 63, v0
    v_lshrrev_b32 v2, 6, v0
    s_nop 0
    v_readfirstlane_b32 s44, v2
    v_add_u32 v3, 0, v1
    v_mul_u32_u24 v3, 2731, v3
    v_lshrrev_b32 v10, 16, v3
    v_add_u32 v3, 64, v1
    v_mul_u32_u24 v3, 2731, v3
    v_lshrrev_b32 v11, 16, v3
    v_add_u32 v3, 128, v1
    v_mul_u32_u24 v3, 2731, v3
    v_lshrrev_b32 v12, 16, v3
    s_waitcnt lgkmcnt(0)
    s_mov_b32 s16, s10
    s_mov_b32 s17, s11
    s_mov_b32 s12, s8
    s_mov_b32 s13, s9
    s_mov_b32 s8, s6
    s_mov_b32 s9, s7
    s_mov_b32 s6, 100663296
    s_mov_b32 s7, 0x20000
    s_mov_b32 s10, 100663296
    s_mov_b32 s11, 0x20000
    s_mov_b32 s14, 100663296
    s_mov_b32 s15, 0x20000
    s_mov_b32 s18, 100663296
    s_mov_b32 s19, 0x20000
    s_mul_i32 s22, s44, 3072
    s_mul_i32 s33, s44, 24576
    s_lshr_b32 s34, s2, 4
    s_lshl_b32 s34, s34, 3
    s_and_b32 s35, s2, 7
    s_add_u32 s34, s34, s35
    s_lshr_b32 s35, s2, 3
    s_and_b32 s35, s35, 1
    s_mul_i32 s34, s34, 196608
    s_add_u32 s25, s34, s22
    s_mov_b32 s26, s25
    s_add_u32 s32, s25, 25165824
    s_mul_i32 s35, s35, 98304
    s_add_u32 s34, s34, s35
    s_add_u32 s27, s34, s33
    s_mov_b32 s29, s27
    s_mov_b32 s28, s33
    s_and_b32 s36, s44, 1
    s_lshl_b32 s36, s36, 2
    v_lshrrev_b32 v4, 1, v10
    v_or_b32 v5, s36, v4
    v_xor_b32 v5, v5, v1
    v_lshlrev_b32 v216, 4, v5
    v_lshrrev_b32 v4, 1, v11
    v_or_b32 v5, s36, v4
    v_xor_b32 v5, v5, v1
    v_lshlrev_b32 v217, 4, v5
    v_lshrrev_b32 v4, 1, v12
    v_or_b32 v5, s36, v4
    v_xor_b32 v5, v5, v1
    v_lshlrev_b32 v218, 4, v5
    s_add_u32 m0, s22, 98304
    s_nop 0
    buffer_load_dwordx4 v216, s[8:11], s25 offen nt lds
    buffer_load_dwordx4 v217, s[8:11], s25 offen offset:1024 nt lds
    buffer_load_dwordx4 v218, s[8:11], s25 offen offset:2048 nt lds
    s_add_u32 s25, s25, 12288
    s_mov_b32 m0, s28
    s_nop 0
    buffer_load_dwordx4 v216, s[4:7], s27 offen nt lds
    buffer_load_dwordx4 v217, s[4:7], s27 offen offset:1024 nt lds
    buffer_load_dwordx4 v218, s[4:7], s27 offen offset:2048 nt lds
    s_add_u32 s27, s27, 3072
    s_add_u32 s28, s28, 3072
    s_mov_b32 m0, s28
    s_nop 0
    buffer_load_dwordx4 v216, s[4:7], s27 offen nt lds
    buffer_load_dwordx4 v217, s[4:7], s27 offen offset:1024 nt lds
    buffer_load_dwordx4 v218, s[4:7], s27 offen offset:2048 nt lds
    s_add_u32 s27, s27, 3072
    s_add_u32 s28, s28, 3072
    v_and_b32 v5, 2, v10
    v_lshlrev_b32 v5, 1, v5
    v_xor_b32 v5, v5, v1
    v_lshlrev_b32 v219, 4, v5
    v_xor_b32 v5, v10, v1
    v_lshlrev_b32 v5, 4, v5
    v_add_u32 v5, 0, v5
    v_add_u32 v237, s33, v5
    v_and_b32 v5, 2, v11
    v_lshlrev_b32 v5, 1, v5
    v_xor_b32 v5, v5, v1
    v_lshlrev_b32 v220, 4, v5
    v_xor_b32 v5, v11, v1
    v_lshlrev_b32 v5, 4, v5
    v_add_u32 v5, 1024, v5
    v_add_u32 v238, s33, v5
    v_and_b32 v5, 2, v12
    v_lshlrev_b32 v5, 1, v5
    v_xor_b32 v5, v5, v1
    v_lshlrev_b32 v221, 4, v5
    v_xor_b32 v5, v12, v1
    v_lshlrev_b32 v5, 4, v5
    v_add_u32 v5, 2048, v5
    v_add_u32 v239, s33, v5
    v_lshrrev_b32 v8, 4, v1
    v_and_b32 v9, 15, v1
    v_lshlrev_b32 v235, 4, v1
    v_mul_u32_u24 v3, 384, v9
    v_lshrrev_b32 v4, 1, v9
    v_xor_b32 v5, v4, v8
    v_lshlrev_b32 v5, 4, v5
    v_add_u32 v210, v3, v5
    v_and_b32 v5, 3, v4
    v_or_b32 v5, s36, v5
    v_xor_b32 v5, v5, v8
    v_lshlrev_b32 v5, 4, v5
    v_add_u32 v5, v3, v5
    v_add_u32 v234, s33, v5
    v_and_b32 v6, 7, v9
    v_xor_b32 v5, v8, v6
    v_lshlrev_b32 v5, 4, v5
    v_add_u32 v5, v3, v5
    v_add_u32 v236, s33, v5
    v_bfe_u32 v3, v1, 2, 2
    v_lshlrev_b32 v4, 2, v8
    v_add_u32 v4, v4, v3
    v_mul_u32_u24 v4, 384, v4
    v_lshrrev_b32 v5, 1, v3
    v_lshlrev_b32 v5, 6, v5
    v_add_u32 v4, v4, v5
    v_and_b32 v5, 3, v1
    v_lshlrev_b32 v5, 4, v5
    v_add_u32 v215, v4, v5
    v_lshlrev_b32 v255, 7, v1
    v_mov_b32 v3, 0x40000000
    v_cmp_gt_u32 vcc, 24, v1
    s_nop 1
    v_cndmask_b32 v255, v3, v255, vcc
    s_add_u32 s78, s29, 50331648
    s_add_u32 s79, s29, 75497472
    v_mov_b32 v3, 0x3f803f80
    v_accvgpr_write_b32 a252, v3
    v_accvgpr_write_b32 a253, v3
    v_accvgpr_write_b32 a254, v3
    v_accvgpr_write_b32 a255, v3
    s_mov_b32 s20, 0x3dd53b95
    s_mov_b32 s21, 0x44800000
    s_mov_b32 s38, 100663296
    s_mov_b32 s23, 98304
    s_mov_b32 s24, 110592
    s_mov_b32 s31, 0
    v_add_u32 v208, s23, v210
    v_xor_b32 v209, 64, v208
    v_add_u32 v211, 98304, v215
    v_xor_b32 v212, 64, v211
    v_mov_b32 v244, v234
    v_xor_b32 v245, 64, v234
    s_mov_b32 m0, s28
    s_nop 0
    buffer_load_dwordx4 v216, s[4:7], s27 offen nt lds
    buffer_load_dwordx4 v217, s[4:7], s27 offen offset:1024 nt lds
    buffer_load_dwordx4 v218, s[4:7], s27 offen offset:2048 nt lds
    s_add_u32 s27, s27, 3072
    s_add_u32 s28, s28, 3072
    s_mov_b32 m0, s28
    s_nop 0
    buffer_load_dwordx4 v216, s[4:7], s27 offen nt lds
    buffer_load_dwordx4 v217, s[4:7], s27 offen offset:1024 nt lds
    buffer_load_dwordx4 v218, s[4:7], s27 offen offset:2048 nt lds
    s_add_u32 s27, s27, 3072
    s_add_u32 s28, s28, 3072
    s_waitcnt vmcnt(12) lgkmcnt(0)
    s_barrier
    ds_read_b128 a[200:203], v208
    ds_read_b128 a[204:207], v209
    ds_read_b128 a[208:211], v208 offset:128
    ds_read_b128 a[212:215], v209 offset:128
    ds_read_b128 a[216:219], v208 offset:256
    ds_read_b128 a[220:223], v209 offset:256
    ds_read_b128 a[176:179], v208 offset:6144
    ds_read_b128 a[180:183], v209 offset:6144
    ds_read_b128 a[184:187], v208 offset:6272
    ds_read_b128 a[188:191], v209 offset:6272
    ds_read_b128 a[192:195], v208 offset:6400
    ds_read_b128 a[196:199], v209 offset:6400
    s_waitcnt vmcnt(6)
    ds_read_b128 a[80:83], v244
    ds_read_b128 a[84:87], v245
    ds_read_b128 a[88:91], v244 offset:128
    ds_read_b128 a[92:95], v245 offset:128
    ds_read_b128 a[96:99], v244 offset:256
    ds_read_b128 a[100:103], v245 offset:256
    s_waitcnt lgkmcnt(0)
    v_mfma_f32_16x16x32_bf16 v[0:3], a[200:203], a[80:83], 0
    v_mfma_f32_16x16x32_bf16 v[0:3], a[204:207], a[84:87], v[0:3]
    v_mfma_f32_16x16x32_bf16 v[0:3], a[208:211], a[88:91], v[0:3]
    v_mfma_f32_16x16x32_bf16 v[0:3], a[212:215], a[92:95], v[0:3]
    v_mfma_f32_16x16x32_bf16 v[0:3], a[216:219], a[96:99], v[0:3]
    v_mfma_f32_16x16x32_bf16 v[0:3], a[220:223], a[100:103], v[0:3]
    v_mfma_f32_16x16x32_bf16 v[16:19], a[176:179], a[80:83], 0
    v_mfma_f32_16x16x32_bf16 v[16:19], a[180:183], a[84:87], v[16:19]
    v_mfma_f32_16x16x32_bf16 v[16:19], a[184:187], a[88:91], v[16:19]
    v_mfma_f32_16x16x32_bf16 v[16:19], a[188:191], a[92:95], v[16:19]
    v_mfma_f32_16x16x32_bf16 v[16:19], a[192:195], a[96:99], v[16:19]
    v_mfma_f32_16x16x32_bf16 v[16:19], a[196:199], a[100:103], v[16:19]
    s_mov_b32 m0, s28
    s_nop 0
    buffer_load_dwordx4 v216, s[4:7], s27 offen nt lds
    buffer_load_dwordx4 v217, s[4:7], s27 offen offset:1024 nt lds
    buffer_load_dwordx4 v218, s[4:7], s27 offen offset:2048 nt lds
    s_add_u32 s27, s27, 3072
    s_add_u32 s28, s28, 3072
    s_mov_b32 m0, s28
    s_nop 0
    buffer_load_dwordx4 v216, s[4:7], s27 offen nt lds
    buffer_load_dwordx4 v217, s[4:7], s27 offen offset:1024 nt lds
    buffer_load_dwordx4 v218, s[4:7], s27 offen offset:2048 nt lds
    s_add_u32 s27, s27, 3072
    s_add_u32 s28, s28, 3072
    s_waitcnt vmcnt(6)
    ds_read_b128 a[104:107], v244 offset:6144
    ds_read_b128 a[108:111], v245 offset:6144
    ds_read_b128 a[112:115], v244 offset:6272
    ds_read_b128 a[116:119], v245 offset:6272
    ds_read_b128 a[120:123], v244 offset:6400
    ds_read_b128 a[124:127], v245 offset:6400
    s_waitcnt lgkmcnt(0)
    v_mfma_f32_16x16x32_bf16 v[4:7], a[200:203], a[104:107], 0
    v_mfma_f32_16x16x32_bf16 v[4:7], a[204:207], a[108:111], v[4:7]
    v_mfma_f32_16x16x32_bf16 v[4:7], a[208:211], a[112:115], v[4:7]
    v_mfma_f32_16x16x32_bf16 v[4:7], a[212:215], a[116:119], v[4:7]
    v_mfma_f32_16x16x32_bf16 v[4:7], a[216:219], a[120:123], v[4:7]
    v_mfma_f32_16x16x32_bf16 v[4:7], a[220:223], a[124:127], v[4:7]
    v_mfma_f32_16x16x32_bf16 v[20:23], a[176:179], a[104:107], 0
    v_mfma_f32_16x16x32_bf16 v[20:23], a[180:183], a[108:111], v[20:23]
    v_mfma_f32_16x16x32_bf16 v[20:23], a[184:187], a[112:115], v[20:23]
    v_mfma_f32_16x16x32_bf16 v[20:23], a[188:191], a[116:119], v[20:23]
    v_mfma_f32_16x16x32_bf16 v[20:23], a[192:195], a[120:123], v[20:23]
    v_mfma_f32_16x16x32_bf16 v[20:23], a[196:199], a[124:127], v[20:23]
    s_mov_b32 m0, s28
    s_nop 0
    buffer_load_dwordx4 v216, s[4:7], s27 offen nt lds
    buffer_load_dwordx4 v217, s[4:7], s27 offen offset:1024 nt lds
    buffer_load_dwordx4 v218, s[4:7], s27 offen offset:2048 nt lds
    s_add_u32 s27, s27, 3072
    s_add_u32 s28, s28, 3072
    s_mov_b32 m0, s28
    s_nop 0
    buffer_load_dwordx4 v216, s[4:7], s27 offen nt lds
    buffer_load_dwordx4 v217, s[4:7], s27 offen offset:1024 nt lds
    buffer_load_dwordx4 v218, s[4:7], s27 offen offset:2048 nt lds
    s_add_u32 s27, s27, 3072
    s_add_u32 s28, s28, 3072
    s_waitcnt vmcnt(6)
    ds_read_b128 a[128:131], v244 offset:12288
    ds_read_b128 a[132:135], v245 offset:12288
    ds_read_b128 a[136:139], v244 offset:12416
    ds_read_b128 a[140:143], v245 offset:12416
    ds_read_b128 a[144:147], v244 offset:12544
    ds_read_b128 a[148:151], v245 offset:12544
    s_waitcnt lgkmcnt(0)
    v_mfma_f32_16x16x32_bf16 v[8:11], a[200:203], a[128:131], 0
    v_mfma_f32_16x16x32_bf16 v[8:11], a[204:207], a[132:135], v[8:11]
    v_mfma_f32_16x16x32_bf16 v[8:11], a[208:211], a[136:139], v[8:11]
    v_mfma_f32_16x16x32_bf16 v[8:11], a[212:215], a[140:143], v[8:11]
    v_mfma_f32_16x16x32_bf16 v[8:11], a[216:219], a[144:147], v[8:11]
    v_mfma_f32_16x16x32_bf16 v[8:11], a[220:223], a[148:151], v[8:11]
    v_mfma_f32_16x16x32_bf16 v[24:27], a[176:179], a[128:131], 0
    v_mfma_f32_16x16x32_bf16 v[24:27], a[180:183], a[132:135], v[24:27]
    v_mfma_f32_16x16x32_bf16 v[24:27], a[184:187], a[136:139], v[24:27]
    v_mfma_f32_16x16x32_bf16 v[24:27], a[188:191], a[140:143], v[24:27]
    v_mfma_f32_16x16x32_bf16 v[24:27], a[192:195], a[144:147], v[24:27]
    v_mfma_f32_16x16x32_bf16 v[24:27], a[196:199], a[148:151], v[24:27]
    s_add_u32 s27, s29, 25165824
    s_mov_b32 s28, s33
    s_add_u32 m0, s22, 122880
    s_nop 0
    buffer_load_dwordx4 v216, s[8:11], s25 offen nt lds
    buffer_load_dwordx4 v217, s[8:11], s25 offen offset:1024 nt lds
    buffer_load_dwordx4 v218, s[8:11], s25 offen offset:2048 nt lds
    s_add_u32 s25, s25, 12288
    s_add_u32 m0, s22, 135168
    s_nop 0
    buffer_load_dwordx4 v219, s[12:15], s26 offen nt lds
    buffer_load_dwordx4 v220, s[12:15], s26 offen offset:1024 nt lds
    buffer_load_dwordx4 v221, s[12:15], s26 offen offset:2048 nt lds
    s_add_u32 s26, s26, 12288
    s_waitcnt vmcnt(6)
    ds_read_b128 a[152:155], v244 offset:18432
    ds_read_b128 a[156:159], v245 offset:18432
    ds_read_b128 a[160:163], v244 offset:18560
    ds_read_b128 a[164:167], v245 offset:18560
    ds_read_b128 a[168:171], v244 offset:18688
    ds_read_b128 a[172:175], v245 offset:18688
    s_waitcnt lgkmcnt(0)
    v_mfma_f32_16x16x32_bf16 v[12:15], a[200:203], a[152:155], 0
    v_mfma_f32_16x16x32_bf16 v[12:15], a[204:207], a[156:159], v[12:15]
    v_mfma_f32_16x16x32_bf16 v[12:15], a[208:211], a[160:163], v[12:15]
    v_mfma_f32_16x16x32_bf16 v[12:15], a[212:215], a[164:167], v[12:15]
    v_mfma_f32_16x16x32_bf16 v[12:15], a[216:219], a[168:171], v[12:15]
    v_mfma_f32_16x16x32_bf16 v[12:15], a[220:223], a[172:175], v[12:15]
    v_mfma_f32_16x16x32_bf16 v[28:31], a[176:179], a[152:155], 0
    v_mfma_f32_16x16x32_bf16 v[28:31], a[180:183], a[156:159], v[28:31]
    v_mfma_f32_16x16x32_bf16 v[28:31], a[184:187], a[160:163], v[28:31]
    v_mfma_f32_16x16x32_bf16 v[28:31], a[188:191], a[164:167], v[28:31]
    v_mfma_f32_16x16x32_bf16 v[28:31], a[192:195], a[168:171], v[28:31]
    v_mfma_f32_16x16x32_bf16 v[28:31], a[196:199], a[172:175], v[28:31]
    s_waitcnt lgkmcnt(0)
    s_barrier
    s_add_u32 m0, s22, 98304
    s_nop 0
    buffer_load_dwordx4 v216, s[8:11], s25 offen nt lds
    buffer_load_dwordx4 v217, s[8:11], s25 offen offset:1024 nt lds
    buffer_load_dwordx4 v218, s[8:11], s25 offen offset:2048 nt lds
    s_add_u32 s25, s25, 12288
    s_nop 7
    v_max3_f32 v240, v0, v1, v2
    v_max3_f32 v240, v240, v3, v16
    v_max3_f32 v240, v240, v17, v18
    v_max_f32 v240, v240, v19
    v_max3_f32 v241, v4, v5, v6
    v_max3_f32 v241, v241, v7, v20
    v_max3_f32 v241, v241, v21, v22
    v_max_f32 v241, v241, v23
    v_max3_f32 v242, v8, v9, v10
    v_max3_f32 v242, v242, v11, v24
    v_max3_f32 v242, v242, v25, v26
    v_max_f32 v242, v242, v27
    v_max3_f32 v243, v12, v13, v14
    v_max3_f32 v243, v243, v15, v28
    v_max3_f32 v243, v243, v29, v30
    v_max_f32 v243, v243, v31
    s_nop 1
    v_permlane32_swap_b32 v240, v241
    v_permlane32_swap_b32 v242, v243
    v_max_f32 v240, v240, v241
    v_max_f32 v242, v242, v243
    s_nop 1
    v_permlane16_swap_b32 v240, v242
    v_max_f32 v240, v240, v242
    v_mul_f32 v222, 0xbdd53b95, v240
    v_add_f32 v222, 0xc1000000, v222
    v_mov_b32 v224, v222
    s_nop 1
    v_permlane16_swap_b32 v222, v224
    v_mov_b32 v223, v222
    v_mov_b32 v225, v224
    s_nop 0
    v_permlane32_swap_b32 v222, v223
    v_permlane32_swap_b32 v224, v225
    v_fma_f32 v0, v0, s20, v222
    v_fma_f32 v1, v1, s20, v222
    v_fma_f32 v2, v2, s20, v222
    v_fma_f32 v3, v3, s20, v222
    v_exp_f32 v200, v0
    v_exp_f32 v201, v1
    v_fma_f32 v16, v16, s20, v222
    v_fma_f32 v17, v17, s20, v222
    v_exp_f32 v202, v2
    v_exp_f32 v203, v3
    v_cvt_pk_bf16_f32 v176, v200, v201
    v_fma_f32 v18, v18, s20, v222
    v_fma_f32 v19, v19, s20, v222
    v_exp_f32 v204, v16
    v_exp_f32 v205, v17
    v_cvt_pk_bf16_f32 v177, v202, v203
    v_or_b32 v230, v176, v177
    v_fma_f32 v4, v4, s20, v223
    v_fma_f32 v5, v5, s20, v223
    v_exp_f32 v200, v18
    v_exp_f32 v201, v19
    v_cvt_pk_bf16_f32 v178, v204, v205
    v_fma_f32 v6, v6, s20, v223
    v_fma_f32 v7, v7, s20, v223
    v_exp_f32 v202, v4
    s_waitcnt vmcnt(6) lgkmcnt(0)
    s_barrier
    ds_read_b128 a[176:179], v208 offset:24576
    s_add_u32 m0, s22, 110592
    s_nop 0
    v_exp_f32 v203, v5
    v_cvt_pk_bf16_f32 v179, v200, v201
    v_or3_b32 v230, v230, v178, v179
    buffer_load_dwordx4 v219, s[12:15], s26 offen nt lds
    ds_read_b128 a[180:183], v209 offset:24576
    v_fma_f32 v20, v20, s20, v223
    v_fma_f32 v21, v21, s20, v223
    v_exp_f32 v204, v6
    ds_read_b128 a[184:187], v208 offset:24704
    v_exp_f32 v205, v7
    buffer_load_dwordx4 v220, s[12:15], s26 offen offset:1024 nt lds
    ds_read_b128 a[188:191], v209 offset:24704
    v_cvt_pk_bf16_f32 v184, v202, v203
    v_fma_f32 v22, v22, s20, v223
    v_fma_f32 v23, v23, s20, v223
    v_exp_f32 v200, v20
    ds_read_b128 a[192:195], v208 offset:24832
    v_exp_f32 v201, v21
    buffer_load_dwordx4 v221, s[12:15], s26 offen offset:2048 nt lds
    ds_read_b128 a[196:199], v209 offset:24832
    v_cvt_pk_bf16_f32 v185, v204, v205
    v_or3_b32 v230, v230, v184, v185
    v_exp_f32 v202, v22
    v_exp_f32 v203, v23
    v_cvt_pk_bf16_f32 v186, v200, v201
    v_cvt_pk_bf16_f32 v187, v202, v203
    v_or3_b32 v230, v230, v186, v187
    s_add_u32 s26, s26, 12288
    v_fma_f32 v8, v8, s20, v224
    v_fma_f32 v9, v9, s20, v224
    v_fma_f32 v10, v10, s20, v224
    v_fma_f32 v11, v11, s20, v224
L_block:
    s_mov_b32 s30, 0
    s_waitcnt lgkmcnt(0)
    v_mfma_f32_16x16x32_bf16 v[32:35], a[176:179], a[80:83], 0
    v_exp_f32 v200, v8
    v_mfma_f32_16x16x32_bf16 v[32:35], a[180:183], a[84:87], v[32:35]
    ds_read_b128 a[200:203], v208 offset:30720
    ds_read_b128 a[224:227], v237
    v_mfma_f32_16x16x32_bf16 v[32:35], a[184:187], a[88:91], v[32:35]
    ds_read_b128 a[228:231], v238
    v_fma_f32 v24, v24, s20, v224
    v_mfma_f32_16x16x32_bf16 v[32:35], a[188:191], a[92:95], v[32:35]
    ds_read_b128 a[204:207], v209 offset:30720
    v_add_u32 v237, 3072, v237
    v_mfma_f32_16x16x32_bf16 v[32:35], a[192:195], a[96:99], v[32:35]
    v_add_u32 v238, 3072, v238
    v_fma_f32 v25, v25, s20, v224
    v_mfma_f32_16x16x32_bf16 v[32:35], a[196:199], a[100:103], v[32:35]
    ds_read_b128 a[208:211], v208 offset:30848
    ds_read_b128 a[232:235], v239
    v_mfma_f32_16x16x32_bf16 v[36:39], a[176:179], a[104:107], 0
    v_exp_f32 v201, v9
    v_mfma_f32_16x16x32_bf16 v[36:39], a[180:183], a[108:111], v[36:39]
    ds_read_b128 a[212:215], v209 offset:30848
    v_add_u32 v239, 3072, v239
    v_cvt_pk_bf16_f32 v192, v200, v201
    v_mfma_f32_16x16x32_bf16 v[36:39], a[184:187], a[112:115], v[36:39]
    v_exp_f32 v202, v10
    v_mfma_f32_16x16x32_bf16 v[36:39], a[188:191], a[116:119], v[36:39]
    ds_read_b128 a[216:219], v208 offset:30976
    v_fma_f32 v26, v26, s20, v224
    v_mfma_f32_16x16x32_bf16 v[36:39], a[192:195], a[120:123], v[36:39]
    v_exp_f32 v203, v11
    v_mfma_f32_16x16x32_bf16 v[36:39], a[196:199], a[124:127], v[36:39]
    ds_read_b128 a[220:223], v209 offset:30976
    v_cvt_pk_bf16_f32 v193, v202, v203
    v_mfma_f32_16x16x32_bf16 v[40:43], a[176:179], a[128:131], 0
    s_waitcnt lgkmcnt(7)
    buffer_store_dwordx4 a[224:227], v235, s[16:19], s38 offen nt
    v_mfma_f32_16x16x32_bf16 v[40:43], a[180:183], a[132:135], v[40:43]
    v_exp_f32 v204, v24
    v_mfma_f32_16x16x32_bf16 v[40:43], a[184:187], a[136:139], v[40:43]
    v_exp_f32 v205, v25
    v_mfma_f32_16x16x32_bf16 v[40:43], a[188:191], a[140:143], v[40:43]
    v_exp_f32 v200, v26
    v_cvt_pk_bf16_f32 v194, v204, v205
    v_mfma_f32_16x16x32_bf16 v[40:43], a[192:195], a[144:147], v[40:43]
    v_fma_f32 v27, v27, s20, v224
    v_fma_f32 v12, v12, s20, v225
    v_mfma_f32_16x16x32_bf16 v[40:43], a[196:199], a[148:151], v[40:43]
    s_mov_b32 m0, s28
    v_fma_f32 v13, v13, s20, v225
    v_mfma_f32_16x16x32_bf16 v[44:47], a[176:179], a[152:155], 0
    s_waitcnt lgkmcnt(3)
    buffer_load_dwordx4 v216, s[4:7], s27 offen nt lds
    v_mfma_f32_16x16x32_bf16 v[44:47], a[180:183], a[156:159], v[44:47]
    v_exp_f32 v201, v27
    v_mfma_f32_16x16x32_bf16 v[44:47], a[184:187], a[160:163], v[44:47]
    v_exp_f32 v202, v12
    v_mfma_f32_16x16x32_bf16 v[44:47], a[188:191], a[164:167], v[44:47]
    v_exp_f32 v203, v13
    v_mfma_f32_16x16x32_bf16 v[44:47], a[192:195], a[168:171], v[44:47]
    buffer_load_dwordx4 v217, s[4:7], s27 offen offset:1024 nt lds
    v_mfma_f32_16x16x32_bf16 v[44:47], a[196:199], a[172:175], v[44:47]
    v_cvt_pk_bf16_f32 v195, v200, v201
    v_cvt_pk_bf16_f32 v196, v202, v203
    s_waitcnt lgkmcnt(0)
    v_mfma_f32_16x16x32_bf16 v[48:51], a[200:203], a[80:83], 0
    v_fma_f32 v14, v14, s20, v225
    v_fma_f32 v15, v15, s20, v225
    v_mfma_f32_16x16x32_bf16 v[48:51], a[204:207], a[84:87], v[48:51]
    v_exp_f32 v204, v14
    v_mfma_f32_16x16x32_bf16 v[48:51], a[208:211], a[88:91], v[48:51]
    buffer_load_dwordx4 v218, s[4:7], s27 offen offset:2048 nt lds
    v_mfma_f32_16x16x32_bf16 v[48:51], a[212:215], a[92:95], v[48:51]
    s_add_u32 s27, s27, 3072
    s_add_u32 s28, s28, 3072
    v_mfma_f32_16x16x32_bf16 v[48:51], a[216:219], a[96:99], v[48:51]
    v_exp_f32 v205, v15
    v_mfma_f32_16x16x32_bf16 v[48:51], a[220:223], a[100:103], v[48:51]
    v_cvt_pk_bf16_f32 v197, v204, v205
    v_fma_f32 v28, v28, s20, v225
    v_mfma_f32_16x16x32_bf16 v[52:55], a[200:203], a[104:107], 0
    v_fma_f32 v29, v29, s20, v225
    s_waitcnt vmcnt(10) lgkmcnt(0)
    v_mfma_f32_16x16x32_bf16 v[52:55], a[204:207], a[108:111], v[52:55]
    s_barrier
    v_fma_f32 v30, v30, s20, v225
    v_mfma_f32_16x16x32_bf16 v[52:55], a[208:211], a[112:115], v[52:55]
    ds_read_b64_tr_b16 a[176:177], v211 offset:36864
    v_fma_f32 v31, v31, s20, v225
    v_mfma_f32_16x16x32_bf16 v[52:55], a[212:215], a[116:119], v[52:55]
    ds_read_b64_tr_b16 a[178:179], v211 offset:43008
    s_add_u32 m0, s22, 122880
    v_mfma_f32_16x16x32_bf16 v[52:55], a[216:219], a[120:123], v[52:55]
    ds_read_b64_tr_b16 a[180:181], v211 offset:36872
    buffer_load_dwordx4 v216, s[8:11], s25 offen nt lds
    v_mfma_f32_16x16x32_bf16 v[52:55], a[220:223], a[124:127], v[52:55]
    ds_read_b64_tr_b16 a[182:183], v211 offset:43016
    v_or3_b32 v230, v230, v192, v193
    v_mfma_f32_16x16x32_bf16 v[56:59], a[200:203], a[128:131], 0
    ds_read_b64_tr_b16 a[184:185], v212 offset:36864
    v_or3_b32 v230, v230, v194, v195
    v_mfma_f32_16x16x32_bf16 v[56:59], a[204:207], a[132:135], v[56:59]
    ds_read_b64_tr_b16 a[186:187], v212 offset:43008
    v_or3_b32 v230, v230, v196, v197
    v_mfma_f32_16x16x32_bf16 v[56:59], a[208:211], a[136:139], v[56:59]
    buffer_load_dwordx4 v217, s[8:11], s25 offen offset:1024 nt lds
    v_mfma_f32_16x16x32_bf16 v[56:59], a[212:215], a[140:143], v[56:59]
    v_exp_f32 v200, v28
    v_exp_f32 v201, v29
    v_mfma_f32_16x16x32_bf16 v[56:59], a[216:219], a[144:147], v[56:59]
    ds_read_b64_tr_b16 a[188:189], v212 offset:36872
    v_cvt_pk_bf16_f32 v198, v200, v201
    v_mfma_f32_16x16x32_bf16 v[56:59], a[220:223], a[148:151], v[56:59]
    ds_read_b64_tr_b16 a[190:191], v212 offset:43016
    v_exp_f32 v202, v30
    v_mfma_f32_16x16x32_bf16 v[60:63], a[200:203], a[152:155], 0
    buffer_load_dwordx4 v218, s[8:11], s25 offen offset:2048 nt lds
    v_mfma_f32_16x16x32_bf16 v[60:63], a[204:207], a[156:159], v[60:63]
    v_exp_f32 v203, v31
    v_mfma_f32_16x16x32_bf16 v[60:63], a[208:211], a[160:163], v[60:63]
    ds_read_b64_tr_b16 a[192:193], v211 offset:36992
    v_cvt_pk_bf16_f32 v199, v202, v203
    v_mfma_f32_16x16x32_bf16 v[60:63], a[212:215], a[164:167], v[60:63]
    ds_read_b64_tr_b16 a[194:195], v211 offset:43136
    v_or3_b32 v230, v230, v198, v199
    v_mfma_f32_16x16x32_bf16 v[60:63], a[216:219], a[168:171], v[60:63]
    s_add_u32 s25, s25, 12288
    v_and_b32 v230, 0x40004000, v230
    v_mfma_f32_16x16x32_bf16 v[60:63], a[220:223], a[172:175], v[60:63]
    v_cmp_ne_u32 vcc, 0, v230
    s_cbranch_vccnz L_rare_b0e
L_ret_b0e:
    s_waitcnt lgkmcnt(6)
    v_mfma_f32_16x16x32_bf16 v[64:67], a[176:179], v[176:179], 0
    ds_read_b64_tr_b16 a[196:197], v211 offset:37000
    v_fma_f32 v32, v32, s20, v222
    v_mfma_f32_16x16x32_bf16 v[68:71], a[176:179], v[184:187], 0
    ds_read_b64_tr_b16 a[198:199], v211 offset:43144
    v_fma_f32 v33, v33, s20, v222
    v_mfma_f32_16x16x32_bf16 v[72:75], a[176:179], v[192:195], 0
    v_exp_f32 v200, v32
    v_mfma_f32_16x16x32_bf16 v[76:79], a[176:179], v[196:199], 0
    ds_read_b64_tr_b16 a[176:177], v212 offset:36992
    v_fma_f32 v34, v34, s20, v222
    v_mfma_f32_16x16x32_bf16 v[80:83], a[180:183], v[176:179], 0
    ds_read_b64_tr_b16 a[178:179], v212 offset:43136
    v_fma_f32 v35, v35, s20, v222
    v_mfma_f32_16x16x32_bf16 v[84:87], a[180:183], v[184:187], 0
    v_exp_f32 v201, v33
    v_mfma_f32_16x16x32_bf16 v[88:91], a[180:183], v[192:195], 0
    v_exp_f32 v202, v34
    v_mfma_f32_16x16x32_bf16 v[92:95], a[180:183], v[196:199], 0
    ds_read_b64_tr_b16 a[180:181], v212 offset:37000
    s_waitcnt lgkmcnt(7)
    v_mfma_f32_16x16x32_bf16 v[96:99], a[184:187], v[176:179], 0
    ds_read_b64_tr_b16 a[182:183], v212 offset:43144
    v_cvt_pk_bf16_f32 v180, v200, v201
    v_mfma_f32_16x16x32_bf16 v[100:103], a[184:187], v[184:187], 0
    v_exp_f32 v203, v35
    v_mfma_f32_16x16x32_bf16 a[236:239], a[252:255], v[176:179], 0
    v_cvt_pk_bf16_f32 v181, v202, v203
    v_fma_f32 v48, v48, s20, v222
    v_mfma_f32_16x16x32_bf16 v[104:107], a[184:187], v[192:195], 0
    v_exp_f32 v204, v48
    v_mfma_f32_16x16x32_bf16 v[108:111], a[184:187], v[196:199], 0
    ds_read_b64_tr_b16 a[184:185], v211 offset:37120
    v_fma_f32 v49, v49, s20, v222
    v_mfma_f32_16x16x32_bf16 v[112:115], a[188:191], v[176:179], 0
    ds_read_b64_tr_b16 a[186:187], v211 offset:43264
    buffer_store_dwordx4 a[228:231], v235, s[16:19], s38 offen offset:1024 nt
    v_mfma_f32_16x16x32_bf16 v[116:119], a[188:191], v[184:187], 0
    v_exp_f32 v205, v49
    v_mfma_f32_16x16x32_bf16 v[120:123], a[188:191], v[192:195], 0
    v_cvt_pk_bf16_f32 v182, v204, v205
    v_fma_f32 v50, v50, s20, v222
    v_mfma_f32_16x16x32_bf16 v[124:127], a[188:191], v[196:199], 0
    ds_read_b64_tr_b16 a[188:189], v211 offset:37128
    s_waitcnt lgkmcnt(7)
    v_mfma_f32_16x16x32_bf16 v[128:131], a[192:195], v[176:179], 0
    ds_read_b64_tr_b16 a[190:191], v211 offset:43272
    v_fma_f32 v51, v51, s20, v222
    v_mfma_f32_16x16x32_bf16 v[132:135], a[192:195], v[184:187], 0
    v_exp_f32 v200, v50
    v_mfma_f32_16x16x32_bf16 v[136:139], a[192:195], v[192:195], 0
    v_exp_f32 v201, v51
    v_mfma_f32_16x16x32_bf16 v[140:143], a[192:195], v[196:199], 0
    ds_read_b64_tr_b16 a[192:193], v212 offset:37120
    v_cvt_pk_bf16_f32 v183, v200, v201
    v_mfma_f32_16x16x32_bf16 v[144:147], a[196:199], v[176:179], 0
    ds_read_b64_tr_b16 a[194:195], v212 offset:43264
    v_fma_f32 v36, v36, s20, v223
    v_mfma_f32_16x16x32_bf16 v[148:151], a[196:199], v[184:187], 0
    v_exp_f32 v202, v36
    v_mfma_f32_16x16x32_bf16 a[240:243], a[252:255], v[184:187], 0
    v_fma_f32 v37, v37, s20, v223
    v_fma_f32 v38, v38, s20, v223
    v_mfma_f32_16x16x32_bf16 v[152:155], a[196:199], v[192:195], 0
    v_exp_f32 v203, v37
    v_mfma_f32_16x16x32_bf16 v[156:159], a[196:199], v[196:199], 0
    ds_read_b64_tr_b16 a[196:197], v212 offset:37128
    s_waitcnt lgkmcnt(7)
    v_mfma_f32_16x16x32_bf16 v[160:163], a[176:179], v[176:179], 0
    ds_read_b64_tr_b16 a[198:199], v212 offset:43272
    v_cvt_pk_bf16_f32 v188, v202, v203
    v_mfma_f32_16x16x32_bf16 v[164:167], a[176:179], v[184:187], 0
    v_exp_f32 v204, v38
    v_mfma_f32_16x16x32_bf16 v[168:171], a[176:179], v[192:195], 0
    v_fma_f32 v39, v39, s20, v223
    v_fma_f32 v52, v52, s20, v223
    v_mfma_f32_16x16x32_bf16 v[172:175], a[176:179], v[196:199], 0
    v_exp_f32 v205, v39
    v_mfma_f32_16x16x32_bf16 a[0:3], a[180:183], v[176:179], 0
    buffer_store_dwordx4 a[232:235], v235, s[16:19], s38 offen offset:2048 nt
    s_add_u32 s38, s38, 3072
    v_mfma_f32_16x16x32_bf16 a[4:7], a[180:183], v[184:187], 0
    v_exp_f32 v200, v52
    v_mfma_f32_16x16x32_bf16 a[8:11], a[180:183], v[192:195], 0
    v_cvt_pk_bf16_f32 v189, v204, v205
    s_waitcnt vmcnt(12) lgkmcnt(0)
    v_mfma_f32_16x16x32_bf16 a[12:15], a[180:183], v[196:199], 0
    s_barrier
    v_mfma_f32_16x16x32_bf16 a[16:19], a[184:187], v[176:179], 0
    ds_read_b128 a[200:203], v208
    v_fma_f32 v53, v53, s20, v223
    v_mfma_f32_16x16x32_bf16 a[20:23], a[184:187], v[184:187], 0
    s_add_u32 m0, s22, 135168
    v_fma_f32 v54, v54, s20, v223
    v_mfma_f32_16x16x32_bf16 a[244:247], a[252:255], v[192:195], 0
    v_exp_f32 v201, v53
    v_mfma_f32_16x16x32_bf16 a[24:27], a[184:187], v[192:195], 0
    buffer_load_dwordx4 v219, s[12:15], s26 offen nt lds
    v_mfma_f32_16x16x32_bf16 a[28:31], a[184:187], v[196:199], 0
    ds_read_b128 a[204:207], v209
    v_cvt_pk_bf16_f32 v190, v200, v201
    v_mfma_f32_16x16x32_bf16 a[32:35], a[188:191], v[176:179], 0
    v_exp_f32 v202, v54
    v_mfma_f32_16x16x32_bf16 a[36:39], a[188:191], v[184:187], 0
    ds_read_b128 a[208:211], v208 offset:128
    v_fma_f32 v55, v55, s20, v223
    v_mfma_f32_16x16x32_bf16 a[40:43], a[188:191], v[192:195], 0
    buffer_load_dwordx4 v220, s[12:15], s26 offen offset:1024 nt lds
    v_mfma_f32_16x16x32_bf16 a[44:47], a[188:191], v[196:199], 0
    ds_read_b128 a[212:215], v209 offset:128
    v_or_b32 v230, v180, v181
    v_mfma_f32_16x16x32_bf16 a[48:51], a[192:195], v[176:179], 0
    v_exp_f32 v203, v55
    v_mfma_f32_16x16x32_bf16 a[52:55], a[192:195], v[184:187], 0
    ds_read_b128 a[216:219], v208 offset:256
    v_cvt_pk_bf16_f32 v191, v202, v203
    v_mfma_f32_16x16x32_bf16 a[56:59], a[192:195], v[192:195], 0
    buffer_load_dwordx4 v221, s[12:15], s26 offen offset:2048 nt lds
    v_mfma_f32_16x16x32_bf16 a[60:63], a[192:195], v[196:199], 0
    ds_read_b128 a[220:223], v209 offset:256
    v_or3_b32 v230, v230, v182, v183
    v_mfma_f32_16x16x32_bf16 a[64:67], a[196:199], v[176:179], 0
    v_or3_b32 v230, v230, v188, v189
    v_or3_b32 v230, v230, v190, v191
    v_mfma_f32_16x16x32_bf16 a[68:71], a[196:199], v[184:187], 0
    v_fma_f32 v40, v40, s20, v224
    v_fma_f32 v41, v41, s20, v224
    v_mfma_f32_16x16x32_bf16 a[248:251], a[252:255], v[196:199], 0
    v_fma_f32 v42, v42, s20, v224
    v_fma_f32 v43, v43, s20, v224
    v_mfma_f32_16x16x32_bf16 a[72:75], a[196:199], v[192:195], 0
    s_add_u32 s26, s26, 12288
    v_mfma_f32_16x16x32_bf16 a[76:79], a[196:199], v[196:199], 0
    s_waitcnt lgkmcnt(0)
    v_mfma_f32_16x16x32_bf16 v[0:3], a[200:203], a[80:83], 0
    v_exp_f32 v200, v40
    v_mfma_f32_16x16x32_bf16 v[0:3], a[204:207], a[84:87], v[0:3]
    ds_read_b128 a[176:179], v208 offset:6144
    ds_read_b128 a[224:227], v237
    v_mfma_f32_16x16x32_bf16 v[0:3], a[208:211], a[88:91], v[0:3]
    ds_read_b128 a[228:231], v238
    v_fma_f32 v56, v56, s20, v224
    v_mfma_f32_16x16x32_bf16 v[0:3], a[212:215], a[92:95], v[0:3]
    ds_read_b128 a[180:183], v209 offset:6144
    v_add_u32 v237, 3072, v237
    v_mfma_f32_16x16x32_bf16 v[0:3], a[216:219], a[96:99], v[0:3]
    v_add_u32 v238, 3072, v238
    v_fma_f32 v57, v57, s20, v224
    v_mfma_f32_16x16x32_bf16 v[0:3], a[220:223], a[100:103], v[0:3]
    ds_read_b128 a[184:187], v208 offset:6272
    ds_read_b128 a[232:235], v239
    v_mfma_f32_16x16x32_bf16 v[4:7], a[200:203], a[104:107], 0
    v_exp_f32 v201, v41
    v_mfma_f32_16x16x32_bf16 v[4:7], a[204:207], a[108:111], v[4:7]
    ds_read_b128 a[188:191], v209 offset:6272
    v_add_u32 v239, 3072, v239
    v_mfma_f32_16x16x32_bf16 v[4:7], a[208:211], a[112:115], v[4:7]
    v_exp_f32 v202, v42
    v_mfma_f32_16x16x32_bf16 v[4:7], a[212:215], a[116:119], v[4:7]
    ds_read_b128 a[192:195], v208 offset:6400
    v_cvt_pk_bf16_f32 v192, v200, v201
    v_mfma_f32_16x16x32_bf16 v[4:7], a[216:219], a[120:123], v[4:7]
    v_exp_f32 v203, v43
    v_mfma_f32_16x16x32_bf16 v[4:7], a[220:223], a[124:127], v[4:7]
    ds_read_b128 a[196:199], v209 offset:6400
    v_exp_f32 v204, v56
    v_mfma_f32_16x16x32_bf16 v[8:11], a[200:203], a[128:131], 0
    v_exp_f32 v205, v57
    v_mfma_f32_16x16x32_bf16 v[8:11], a[204:207], a[132:135], v[8:11]
    v_cvt_pk_bf16_f32 v193, v202, v203
    v_cvt_pk_bf16_f32 v194, v204, v205
    v_mfma_f32_16x16x32_bf16 v[8:11], a[208:211], a[136:139], v[8:11]
    v_fma_f32 v58, v58, s20, v224
    v_fma_f32 v59, v59, s20, v224
    v_mfma_f32_16x16x32_bf16 v[8:11], a[212:215], a[140:143], v[8:11]
    v_exp_f32 v200, v58
    v_mfma_f32_16x16x32_bf16 v[8:11], a[216:219], a[144:147], v[8:11]
    v_exp_f32 v201, v59
    v_mfma_f32_16x16x32_bf16 v[8:11], a[220:223], a[148:151], v[8:11]
    s_mov_b32 m0, s28
    v_cvt_pk_bf16_f32 v195, v200, v201
    v_mfma_f32_16x16x32_bf16 v[12:15], a[200:203], a[152:155], 0
    s_waitcnt lgkmcnt(3)
    buffer_load_dwordx4 v216, s[4:7], s27 offen nt lds
    v_mfma_f32_16x16x32_bf16 v[12:15], a[204:207], a[156:159], v[12:15]
    v_fma_f32 v44, v44, s20, v225
    v_fma_f32 v45, v45, s20, v225
    v_mfma_f32_16x16x32_bf16 v[12:15], a[208:211], a[160:163], v[12:15]
    v_exp_f32 v202, v44
    v_mfma_f32_16x16x32_bf16 v[12:15], a[212:215], a[164:167], v[12:15]
    v_exp_f32 v203, v45
    v_mfma_f32_16x16x32_bf16 v[12:15], a[216:219], a[168:171], v[12:15]
    buffer_load_dwordx4 v217, s[4:7], s27 offen offset:1024 nt lds
    v_mfma_f32_16x16x32_bf16 v[12:15], a[220:223], a[172:175], v[12:15]
    v_cvt_pk_bf16_f32 v196, v202, v203
    v_fma_f32 v46, v46, s20, v225
    s_waitcnt lgkmcnt(0)
    v_mfma_f32_16x16x32_bf16 v[16:19], a[176:179], a[80:83], 0
    v_exp_f32 v204, v46
    v_mfma_f32_16x16x32_bf16 v[16:19], a[180:183], a[84:87], v[16:19]
    v_fma_f32 v47, v47, s20, v225
    v_fma_f32 v60, v60, s20, v225
    v_mfma_f32_16x16x32_bf16 v[16:19], a[184:187], a[88:91], v[16:19]
    buffer_load_dwordx4 v218, s[4:7], s27 offen offset:2048 nt lds
    v_mfma_f32_16x16x32_bf16 v[16:19], a[188:191], a[92:95], v[16:19]
    s_add_u32 s27, s27, 3072
    s_add_u32 s28, s28, 3072
    v_mfma_f32_16x16x32_bf16 v[16:19], a[192:195], a[96:99], v[16:19]
    v_exp_f32 v205, v47
    v_mfma_f32_16x16x32_bf16 v[16:19], a[196:199], a[100:103], v[16:19]
    v_exp_f32 v200, v60
    v_mfma_f32_16x16x32_bf16 v[20:23], a[176:179], a[104:107], 0
    v_cvt_pk_bf16_f32 v197, v204, v205
    s_waitcnt vmcnt(15) lgkmcnt(0)
    v_mfma_f32_16x16x32_bf16 v[20:23], a[180:183], a[108:111], v[20:23]
    s_barrier
    v_mfma_f32_16x16x32_bf16 v[20:23], a[184:187], a[112:115], v[20:23]
    ds_read_b64_tr_b16 a[200:201], v211 offset:12288
    v_fma_f32 v61, v61, s20, v225
    v_mfma_f32_16x16x32_bf16 v[20:23], a[188:191], a[116:119], v[20:23]
    ds_read_b64_tr_b16 a[202:203], v211 offset:18432
    s_add_u32 m0, s22, 98304
    v_mfma_f32_16x16x32_bf16 v[20:23], a[192:195], a[120:123], v[20:23]
    ds_read_b64_tr_b16 a[204:205], v211 offset:12296
    buffer_load_dwordx4 v216, s[8:11], s25 offen nt lds
    v_mfma_f32_16x16x32_bf16 v[20:23], a[196:199], a[124:127], v[20:23]
    ds_read_b64_tr_b16 a[206:207], v211 offset:18440
    v_exp_f32 v201, v61
    v_mfma_f32_16x16x32_bf16 v[24:27], a[176:179], a[128:131], 0
    ds_read_b64_tr_b16 a[208:209], v212 offset:12288
    v_cvt_pk_bf16_f32 v198, v200, v201
    v_mfma_f32_16x16x32_bf16 v[24:27], a[180:183], a[132:135], v[24:27]
    ds_read_b64_tr_b16 a[210:211], v212 offset:18432
    v_fma_f32 v62, v62, s20, v225
    v_mfma_f32_16x16x32_bf16 v[24:27], a[184:187], a[136:139], v[24:27]
    buffer_load_dwordx4 v217, s[8:11], s25 offen offset:1024 nt lds
    v_mfma_f32_16x16x32_bf16 v[24:27], a[188:191], a[140:143], v[24:27]
    v_exp_f32 v202, v62
    v_mfma_f32_16x16x32_bf16 v[24:27], a[192:195], a[144:147], v[24:27]
    ds_read_b64_tr_b16 a[212:213], v212 offset:12296
    v_fma_f32 v63, v63, s20, v225
    v_mfma_f32_16x16x32_bf16 v[24:27], a[196:199], a[148:151], v[24:27]
    ds_read_b64_tr_b16 a[214:215], v212 offset:18440
    v_or3_b32 v230, v230, v192, v193
    v_mfma_f32_16x16x32_bf16 v[28:31], a[176:179], a[152:155], 0
    buffer_load_dwordx4 v218, s[8:11], s25 offen offset:2048 nt lds
    v_mfma_f32_16x16x32_bf16 v[28:31], a[180:183], a[156:159], v[28:31]
    v_exp_f32 v203, v63
    v_mfma_f32_16x16x32_bf16 v[28:31], a[184:187], a[160:163], v[28:31]
    ds_read_b64_tr_b16 a[216:217], v211 offset:12416
    v_cvt_pk_bf16_f32 v199, v202, v203
    v_mfma_f32_16x16x32_bf16 v[28:31], a[188:191], a[164:167], v[28:31]
    ds_read_b64_tr_b16 a[218:219], v211 offset:18560
    v_or3_b32 v230, v230, v194, v195
    v_mfma_f32_16x16x32_bf16 v[28:31], a[192:195], a[168:171], v[28:31]
    s_add_u32 s25, s25, 12288
    v_or3_b32 v230, v230, v196, v197
    v_mfma_f32_16x16x32_bf16 v[28:31], a[196:199], a[172:175], v[28:31]
    v_or3_b32 v230, v230, v198, v199
    v_and_b32 v230, 0x40004000, v230
    v_cmp_ne_u32 vcc, 0, v230
    s_cbranch_vccnz L_rare_b0o
L_ret_b0o:
    s_waitcnt lgkmcnt(6)
    v_mfma_f32_16x16x32_bf16 v[64:67], a[200:203], v[180:183], v[64:67]
    ds_read_b64_tr_b16 a[220:221], v211 offset:12424
    v_fma_f32 v0, v0, s20, v222
    v_mfma_f32_16x16x32_bf16 v[68:71], a[200:203], v[188:191], v[68:71]
    ds_read_b64_tr_b16 a[222:223], v211 offset:18568
    v_fma_f32 v1, v1, s20, v222
    v_mfma_f32_16x16x32_bf16 v[72:75], a[200:203], v[192:195], v[72:75]
    v_exp_f32 v200, v0
    v_mfma_f32_16x16x32_bf16 v[76:79], a[200:203], v[196:199], v[76:79]
    ds_read_b64_tr_b16 a[200:201], v212 offset:12416
    v_fma_f32 v2, v2, s20, v222
    v_mfma_f32_16x16x32_bf16 v[80:83], a[204:207], v[180:183], v[80:83]
    ds_read_b64_tr_b16 a[202:203], v212 offset:18560
    v_fma_f32 v3, v3, s20, v222
    v_mfma_f32_16x16x32_bf16 v[84:87], a[204:207], v[188:191], v[84:87]
    v_exp_f32 v201, v1
    v_mfma_f32_16x16x32_bf16 v[88:91], a[204:207], v[192:195], v[88:91]
    v_exp_f32 v202, v2
    v_mfma_f32_16x16x32_bf16 v[92:95], a[204:207], v[196:199], v[92:95]
    ds_read_b64_tr_b16 a[204:205], v212 offset:12424
    s_waitcnt lgkmcnt(7)
    v_mfma_f32_16x16x32_bf16 v[96:99], a[208:211], v[180:183], v[96:99]
    ds_read_b64_tr_b16 a[206:207], v212 offset:18568
    v_cvt_pk_bf16_f32 v176, v200, v201
    v_mfma_f32_16x16x32_bf16 v[100:103], a[208:211], v[188:191], v[100:103]
    v_exp_f32 v203, v3
    v_mfma_f32_16x16x32_bf16 a[236:239], a[252:255], v[180:183], a[236:239]
    v_cvt_pk_bf16_f32 v177, v202, v203
    v_fma_f32 v16, v16, s20, v222
    v_mfma_f32_16x16x32_bf16 v[104:107], a[208:211], v[192:195], v[104:107]
    v_exp_f32 v204, v16
    v_mfma_f32_16x16x32_bf16 v[108:111], a[208:211], v[196:199], v[108:111]
    ds_read_b64_tr_b16 a[208:209], v211 offset:12544
    v_fma_f32 v17, v17, s20, v222
    v_mfma_f32_16x16x32_bf16 v[112:115], a[212:215], v[180:183], v[112:115]
    ds_read_b64_tr_b16 a[210:211], v211 offset:18688
    v_fma_f32 v18, v18, s20, v222
    v_mfma_f32_16x16x32_bf16 v[116:119], a[212:215], v[188:191], v[116:119]
    v_exp_f32 v205, v17
    v_mfma_f32_16x16x32_bf16 v[120:123], a[212:215], v[192:195], v[120:123]
    v_exp_f32 v200, v18
    v_mfma_f32_16x16x32_bf16 v[124:127], a[212:215], v[196:199], v[124:127]
    ds_read_b64_tr_b16 a[212:213], v211 offset:12552
    s_waitcnt lgkmcnt(7)
    v_mfma_f32_16x16x32_bf16 v[128:131], a[216:219], v[180:183], v[128:131]
    ds_read_b64_tr_b16 a[214:215], v211 offset:18696
    v_cvt_pk_bf16_f32 v178, v204, v205
    v_mfma_f32_16x16x32_bf16 v[132:135], a[216:219], v[188:191], v[132:135]
    v_fma_f32 v19, v19, s20, v222
    v_fma_f32 v4, v4, s20, v223
    v_mfma_f32_16x16x32_bf16 v[136:139], a[216:219], v[192:195], v[136:139]
    v_exp_f32 v201, v19
    v_mfma_f32_16x16x32_bf16 v[140:143], a[216:219], v[196:199], v[140:143]
    ds_read_b64_tr_b16 a[216:217], v212 offset:12544
    v_cvt_pk_bf16_f32 v179, v200, v201
    v_mfma_f32_16x16x32_bf16 v[144:147], a[220:223], v[180:183], v[144:147]
    ds_read_b64_tr_b16 a[218:219], v212 offset:18688
    v_fma_f32 v5, v5, s20, v223
    v_mfma_f32_16x16x32_bf16 v[148:151], a[220:223], v[188:191], v[148:151]
    v_exp_f32 v202, v4
    v_mfma_f32_16x16x32_bf16 a[240:243], a[252:255], v[188:191], a[240:243]
    v_exp_f32 v203, v5
    v_mfma_f32_16x16x32_bf16 v[152:155], a[220:223], v[192:195], v[152:155]
    v_cvt_pk_bf16_f32 v184, v202, v203
    v_fma_f32 v6, v6, s20, v223
    v_mfma_f32_16x16x32_bf16 v[156:159], a[220:223], v[196:199], v[156:159]
    ds_read_b64_tr_b16 a[220:221], v212 offset:12552
    s_waitcnt lgkmcnt(7)
    v_mfma_f32_16x16x32_bf16 v[160:163], a[200:203], v[180:183], v[160:163]
    ds_read_b64_tr_b16 a[222:223], v212 offset:18696
    v_fma_f32 v7, v7, s20, v223
    v_mfma_f32_16x16x32_bf16 v[164:167], a[200:203], v[188:191], v[164:167]
    v_exp_f32 v204, v6
    v_mfma_f32_16x16x32_bf16 v[168:171], a[200:203], v[192:195], v[168:171]
    v_exp_f32 v205, v7
    v_mfma_f32_16x16x32_bf16 v[172:175], a[200:203], v[196:199], v[172:175]
    v_cvt_pk_bf16_f32 v185, v204, v205
    v_fma_f32 v20, v20, s20, v223
    v_mfma_f32_16x16x32_bf16 a[0:3], a[204:207], v[180:183], a[0:3]
    v_exp_f32 v200, v20
    v_mfma_f32_16x16x32_bf16 a[4:7], a[204:207], v[188:191], a[4:7]
    v_fma_f32 v21, v21, s20, v223
    v_fma_f32 v22, v22, s20, v223
    v_mfma_f32_16x16x32_bf16 a[8:11], a[204:207], v[192:195], a[8:11]
    v_fma_f32 v23, v23, s20, v223
    s_waitcnt vmcnt(11) lgkmcnt(0)
    v_mfma_f32_16x16x32_bf16 a[12:15], a[204:207], v[196:199], a[12:15]
    s_barrier
    v_mfma_f32_16x16x32_bf16 a[16:19], a[208:211], v[180:183], a[16:19]
    ds_read_b128 a[176:179], v208 offset:24576
    v_or_b32 v230, v176, v177
    v_mfma_f32_16x16x32_bf16 a[20:23], a[208:211], v[188:191], a[20:23]
    s_add_u32 m0, s22, 110592
    v_or3_b32 v230, v230, v178, v179
    v_mfma_f32_16x16x32_bf16 a[244:247], a[252:255], v[192:195], a[244:247]
    v_exp_f32 v201, v21
    v_mfma_f32_16x16x32_bf16 a[24:27], a[208:211], v[192:195], a[24:27]
    buffer_load_dwordx4 v219, s[12:15], s26 offen nt lds
    v_mfma_f32_16x16x32_bf16 a[28:31], a[208:211], v[196:199], a[28:31]
    ds_read_b128 a[180:183], v209 offset:24576
    v_cvt_pk_bf16_f32 v186, v200, v201
    v_mfma_f32_16x16x32_bf16 a[32:35], a[212:215], v[180:183], a[32:35]
    v_exp_f32 v202, v22
    v_mfma_f32_16x16x32_bf16 a[36:39], a[212:215], v[188:191], a[36:39]
    ds_read_b128 a[184:187], v208 offset:24704
    v_or3_b32 v230, v230, v184, v185
    v_mfma_f32_16x16x32_bf16 a[40:43], a[212:215], v[192:195], a[40:43]
    buffer_load_dwordx4 v220, s[12:15], s26 offen offset:1024 nt lds
    v_mfma_f32_16x16x32_bf16 a[44:47], a[212:215], v[196:199], a[44:47]
    ds_read_b128 a[188:191], v209 offset:24704
    v_fma_f32 v8, v8, s20, v224
    v_mfma_f32_16x16x32_bf16 a[48:51], a[216:219], v[180:183], a[48:51]
    v_exp_f32 v203, v23
    v_mfma_f32_16x16x32_bf16 a[52:55], a[216:219], v[188:191], a[52:55]
    ds_read_b128 a[192:195], v208 offset:24832
    v_cvt_pk_bf16_f32 v187, v202, v203
    v_mfma_f32_16x16x32_bf16 a[56:59], a[216:219], v[192:195], a[56:59]
    buffer_load_dwordx4 v221, s[12:15], s26 offen offset:2048 nt lds
    v_mfma_f32_16x16x32_bf16 a[60:63], a[216:219], v[196:199], a[60:63]
    ds_read_b128 a[196:199], v209 offset:24832
    v_or3_b32 v230, v230, v186, v187
    v_mfma_f32_16x16x32_bf16 a[64:67], a[220:223], v[180:183], a[64:67]
    v_fma_f32 v9, v9, s20, v224
    v_fma_f32 v10, v10, s20, v224
    v_mfma_f32_16x16x32_bf16 a[68:71], a[220:223], v[188:191], a[68:71]
    v_fma_f32 v11, v11, s20, v224
    v_mfma_f32_16x16x32_bf16 a[248:251], a[252:255], v[196:199], a[248:251]
    v_mfma_f32_16x16x32_bf16 a[72:75], a[220:223], v[192:195], a[72:75]
    s_add_u32 s26, s26, 12288
    v_mfma_f32_16x16x32_bf16 a[76:79], a[220:223], v[196:199], a[76:79]
    s_mov_b32 s30, 1
    .p2align 6
L_steady:
    s_cmp_eq_u32 s30, 4
    s_cselect_b32 s78, s79, s78
    s_waitcnt lgkmcnt(0)
    v_mfma_f32_16x16x32_bf16 v[32:35], a[176:179], a[80:83], 0
    v_exp_f32 v200, v8
    v_mfma_f32_16x16x32_bf16 v[32:35], a[180:183], a[84:87], v[32:35]
    ds_read_b128 a[200:203], v208 offset:30720
    v_fma_f32 v24, v24, s20, v224
    v_mfma_f32_16x16x32_bf16 v[32:35], a[184:187], a[88:91], v[32:35]
    v_exp_f32 v201, v9
    v_mfma_f32_16x16x32_bf16 v[32:35], a[188:191], a[92:95], v[32:35]
    ds_read_b128 a[204:207], v209 offset:30720
    v_cvt_pk_bf16_f32 v192, v200, v201
    v_mfma_f32_16x16x32_bf16 v[32:35], a[192:195], a[96:99], v[32:35]
    v_exp_f32 v202, v10
    v_mfma_f32_16x16x32_bf16 v[32:35], a[196:199], a[100:103], v[32:35]
    ds_read_b128 a[208:211], v208 offset:30848
    v_fma_f32 v25, v25, s20, v224
    v_mfma_f32_16x16x32_bf16 v[36:39], a[176:179], a[104:107], 0
    v_exp_f32 v203, v11
    v_mfma_f32_16x16x32_bf16 v[36:39], a[180:183], a[108:111], v[36:39]
    ds_read_b128 a[212:215], v209 offset:30848
    v_cvt_pk_bf16_f32 v193, v202, v203
    v_mfma_f32_16x16x32_bf16 v[36:39], a[184:187], a[112:115], v[36:39]
    buffer_load_dword v254, v255, s[4:7], s78 offen
    v_mfma_f32_16x16x32_bf16 v[36:39], a[188:191], a[116:119], v[36:39]
    ds_read_b128 a[216:219], v208 offset:30976
    s_add_u32 s78, s78, 3072
    v_mfma_f32_16x16x32_bf16 v[36:39], a[192:195], a[120:123], v[36:39]
    v_exp_f32 v204, v24
    v_mfma_f32_16x16x32_bf16 v[36:39], a[196:199], a[124:127], v[36:39]
    ds_read_b128 a[220:223], v209 offset:30976
    v_fma_f32 v26, v26, s20, v224
    v_mfma_f32_16x16x32_bf16 v[40:43], a[176:179], a[128:131], 0
    buffer_store_dwordx4 a[224:227], v235, s[16:19], s38 offen nt
    v_mfma_f32_16x16x32_bf16 v[40:43], a[180:183], a[132:135], v[40:43]
    v_exp_f32 v205, v25
    v_mfma_f32_16x16x32_bf16 v[40:43], a[184:187], a[136:139], v[40:43]
    v_exp_f32 v200, v26
    v_mfma_f32_16x16x32_bf16 v[40:43], a[188:191], a[140:143], v[40:43]
    v_cvt_pk_bf16_f32 v194, v204, v205
    v_fma_f32 v27, v27, s20, v224
    v_mfma_f32_16x16x32_bf16 v[40:43], a[192:195], a[144:147], v[40:43]
    v_exp_f32 v201, v27
    v_mfma_f32_16x16x32_bf16 v[40:43], a[196:199], a[148:151], v[40:43]
    v_cvt_pk_bf16_f32 v195, v200, v201
    v_fma_f32 v12, v12, s20, v225
    v_mfma_f32_16x16x32_bf16 v[44:47], a[176:179], a[152:155], 0
    v_exp_f32 v202, v12
    v_mfma_f32_16x16x32_bf16 v[44:47], a[180:183], a[156:159], v[44:47]
    v_fma_f32 v13, v13, s20, v225
    v_fma_f32 v14, v14, s20, v225
    v_mfma_f32_16x16x32_bf16 v[44:47], a[184:187], a[160:163], v[44:47]
    v_exp_f32 v203, v13
    v_mfma_f32_16x16x32_bf16 v[44:47], a[188:191], a[164:167], v[44:47]
    v_exp_f32 v204, v14
    v_mfma_f32_16x16x32_bf16 v[44:47], a[192:195], a[168:171], v[44:47]
    v_cvt_pk_bf16_f32 v196, v202, v203
    v_fma_f32 v15, v15, s20, v225
    v_mfma_f32_16x16x32_bf16 v[44:47], a[196:199], a[172:175], v[44:47]
    v_fma_f32 v28, v28, s20, v225
    s_waitcnt lgkmcnt(0)
    v_mfma_f32_16x16x32_bf16 v[48:51], a[200:203], a[80:83], 0
    v_exp_f32 v205, v15
    v_mfma_f32_16x16x32_bf16 v[48:51], a[204:207], a[84:87], v[48:51]
    v_exp_f32 v200, v28
    v_mfma_f32_16x16x32_bf16 v[48:51], a[208:211], a[88:91], v[48:51]
    v_cvt_pk_bf16_f32 v197, v204, v205
    v_fma_f32 v29, v29, s20, v225
    v_mfma_f32_16x16x32_bf16 v[48:51], a[212:215], a[92:95], v[48:51]
    v_exp_f32 v201, v29
    v_mfma_f32_16x16x32_bf16 v[48:51], a[216:219], a[96:99], v[48:51]
    v_cvt_pk_bf16_f32 v198, v200, v201
    v_fma_f32 v30, v30, s20, v225
    v_mfma_f32_16x16x32_bf16 v[48:51], a[220:223], a[100:103], v[48:51]
    v_exp_f32 v202, v30
    v_mfma_f32_16x16x32_bf16 v[52:55], a[200:203], a[104:107], 0
    v_fma_f32 v31, v31, s20, v225
    s_waitcnt vmcnt(11) lgkmcnt(0)
    v_mfma_f32_16x16x32_bf16 v[52:55], a[204:207], a[108:111], v[52:55]
    s_barrier
    v_mfma_f32_16x16x32_bf16 v[52:55], a[208:211], a[112:115], v[52:55]
    ds_read_b64_tr_b16 a[176:177], v211 offset:36864
    v_or3_b32 v230, v230, v192, v193
    v_mfma_f32_16x16x32_bf16 v[52:55], a[212:215], a[116:119], v[52:55]
    ds_read_b64_tr_b16 a[178:179], v211 offset:43008
    s_add_u32 m0, s22, 122880
    v_mfma_f32_16x16x32_bf16 v[52:55], a[216:219], a[120:123], v[52:55]
    ds_read_b64_tr_b16 a[180:181], v211 offset:36872
    buffer_load_dwordx4 v216, s[8:11], s25 offen nt lds
    v_mfma_f32_16x16x32_bf16 v[52:55], a[220:223], a[124:127], v[52:55]
    ds_read_b64_tr_b16 a[182:183], v211 offset:43016
    v_or3_b32 v230, v230, v194, v195
    v_mfma_f32_16x16x32_bf16 v[56:59], a[200:203], a[128:131], 0
    ds_read_b64_tr_b16 a[184:185], v212 offset:36864
    v_or3_b32 v230, v230, v196, v197
    v_mfma_f32_16x16x32_bf16 v[56:59], a[204:207], a[132:135], v[56:59]
    ds_read_b64_tr_b16 a[186:187], v212 offset:43008
    v_exp_f32 v203, v31
    v_mfma_f32_16x16x32_bf16 v[56:59], a[208:211], a[136:139], v[56:59]
    buffer_load_dwordx4 v217, s[8:11], s25 offen offset:1024 nt lds
    v_mfma_f32_16x16x32_bf16 v[56:59], a[212:215], a[140:143], v[56:59]
    v_cvt_pk_bf16_f32 v199, v202, v203
    v_or3_b32 v230, v230, v198, v199
    v_mfma_f32_16x16x32_bf16 v[56:59], a[216:219], a[144:147], v[56:59]
    ds_read_b64_tr_b16 a[188:189], v212 offset:36872
    v_and_b32 v230, 0x40004000, v230
    v_mfma_f32_16x16x32_bf16 v[56:59], a[220:223], a[148:151], v[56:59]
    ds_read_b64_tr_b16 a[190:191], v212 offset:43016
    v_cmp_ne_u32 vcc, 0, v230
    v_mfma_f32_16x16x32_bf16 v[60:63], a[200:203], a[152:155], 0
    buffer_load_dwordx4 v218, s[8:11], s25 offen offset:2048 nt lds
    v_mfma_f32_16x16x32_bf16 v[60:63], a[204:207], a[156:159], v[60:63]
    v_mfma_f32_16x16x32_bf16 v[60:63], a[208:211], a[160:163], v[60:63]
    ds_read_b64_tr_b16 a[192:193], v211 offset:36992
    v_mfma_f32_16x16x32_bf16 v[60:63], a[212:215], a[164:167], v[60:63]
    ds_read_b64_tr_b16 a[194:195], v211 offset:43136
    v_mfma_f32_16x16x32_bf16 v[60:63], a[216:219], a[168:171], v[60:63]
    s_add_u32 s25, s25, 12288
    v_mfma_f32_16x16x32_bf16 v[60:63], a[220:223], a[172:175], v[60:63]
    s_cbranch_vccnz L_rare_ste
L_ret_ste:
    s_waitcnt lgkmcnt(6)
    v_mfma_f32_16x16x32_bf16 v[64:67], a[176:179], v[176:179], v[64:67]
    ds_read_b64_tr_b16 a[196:197], v211 offset:37000
    v_fma_f32 v32, v32, s20, v222
    v_mfma_f32_16x16x32_bf16 v[68:71], a[176:179], v[184:187], v[68:71]
    ds_read_b64_tr_b16 a[198:199], v211 offset:43144
    v_fma_f32 v33, v33, s20, v222
    v_mfma_f32_16x16x32_bf16 v[72:75], a[176:179], v[192:195], v[72:75]
    v_exp_f32 v200, v32
    v_mfma_f32_16x16x32_bf16 v[76:79], a[176:179], v[196:199], v[76:79]
    ds_read_b64_tr_b16 a[176:177], v212 offset:36992
    v_fma_f32 v34, v34, s20, v222
    v_mfma_f32_16x16x32_bf16 v[80:83], a[180:183], v[176:179], v[80:83]
    ds_read_b64_tr_b16 a[178:179], v212 offset:43136
    v_fma_f32 v35, v35, s20, v222
    v_mfma_f32_16x16x32_bf16 v[84:87], a[180:183], v[184:187], v[84:87]
    v_exp_f32 v201, v33
    v_mfma_f32_16x16x32_bf16 v[88:91], a[180:183], v[192:195], v[88:91]
    v_exp_f32 v202, v34
    v_mfma_f32_16x16x32_bf16 v[92:95], a[180:183], v[196:199], v[92:95]
    ds_read_b64_tr_b16 a[180:181], v212 offset:37000
    s_waitcnt lgkmcnt(7)
    v_mfma_f32_16x16x32_bf16 v[96:99], a[184:187], v[176:179], v[96:99]
    ds_read_b64_tr_b16 a[182:183], v212 offset:43144
    v_cvt_pk_bf16_f32 v180, v200, v201
    v_mfma_f32_16x16x32_bf16 v[100:103], a[184:187], v[184:187], v[100:103]
    v_exp_f32 v203, v35
    v_mfma_f32_16x16x32_bf16 a[236:239], a[252:255], v[176:179], a[236:239]
    v_cvt_pk_bf16_f32 v181, v202, v203
    v_fma_f32 v48, v48, s20, v222
    v_mfma_f32_16x16x32_bf16 v[104:107], a[184:187], v[192:195], v[104:107]
    v_exp_f32 v204, v48
    v_mfma_f32_16x16x32_bf16 v[108:111], a[184:187], v[196:199], v[108:111]
    ds_read_b64_tr_b16 a[184:185], v211 offset:37120
    v_fma_f32 v49, v49, s20, v222
    v_mfma_f32_16x16x32_bf16 v[112:115], a[188:191], v[176:179], v[112:115]
    ds_read_b64_tr_b16 a[186:187], v211 offset:43264
    buffer_store_dwordx4 a[228:231], v235, s[16:19], s38 offen offset:1024 nt
    v_mfma_f32_16x16x32_bf16 v[116:119], a[188:191], v[184:187], v[116:119]
    v_exp_f32 v205, v49
    v_mfma_f32_16x16x32_bf16 v[120:123], a[188:191], v[192:195], v[120:123]
    v_cvt_pk_bf16_f32 v182, v204, v205
    v_fma_f32 v50, v50, s20, v222
    v_mfma_f32_16x16x32_bf16 v[124:127], a[188:191], v[196:199], v[124:127]
    ds_read_b64_tr_b16 a[188:189], v211 offset:37128
    s_waitcnt lgkmcnt(7)
    v_mfma_f32_16x16x32_bf16 v[128:131], a[192:195], v[176:179], v[128:131]
    ds_read_b64_tr_b16 a[190:191], v211 offset:43272
    v_fma_f32 v51, v51, s20, v222
    v_mfma_f32_16x16x32_bf16 v[132:135], a[192:195], v[184:187], v[132:135]
    v_exp_f32 v200, v50
    v_mfma_f32_16x16x32_bf16 v[136:139], a[192:195], v[192:195], v[136:139]
    v_exp_f32 v201, v51
    v_mfma_f32_16x16x32_bf16 v[140:143], a[192:195], v[196:199], v[140:143]
    ds_read_b64_tr_b16 a[192:193], v212 offset:37120
    v_cvt_pk_bf16_f32 v183, v200, v201
    v_mfma_f32_16x16x32_bf16 v[144:147], a[196:199], v[176:179], v[144:147]
    ds_read_b64_tr_b16 a[194:195], v212 offset:43264
    v_fma_f32 v36, v36, s20, v223
    v_mfma_f32_16x16x32_bf16 v[148:151], a[196:199], v[184:187], v[148:151]
    v_exp_f32 v202, v36
    v_mfma_f32_16x16x32_bf16 a[240:243], a[252:255], v[184:187], a[240:243]
    v_fma_f32 v37, v37, s20, v223
    v_fma_f32 v38, v38, s20, v223
    v_mfma_f32_16x16x32_bf16 v[152:155], a[196:199], v[192:195], v[152:155]
    v_exp_f32 v203, v37
    v_mfma_f32_16x16x32_bf16 v[156:159], a[196:199], v[196:199], v[156:159]
    ds_read_b64_tr_b16 a[196:197], v212 offset:37128
    s_waitcnt lgkmcnt(7)
    v_mfma_f32_16x16x32_bf16 v[160:163], a[176:179], v[176:179], v[160:163]
    ds_read_b64_tr_b16 a[198:199], v212 offset:43272
    v_cvt_pk_bf16_f32 v188, v202, v203
    v_mfma_f32_16x16x32_bf16 v[164:167], a[176:179], v[184:187], v[164:167]
    v_exp_f32 v204, v38
    v_mfma_f32_16x16x32_bf16 v[168:171], a[176:179], v[192:195], v[168:171]
    v_fma_f32 v39, v39, s20, v223
    v_fma_f32 v52, v52, s20, v223
    v_mfma_f32_16x16x32_bf16 v[172:175], a[176:179], v[196:199], v[172:175]
    v_exp_f32 v205, v39
    v_mfma_f32_16x16x32_bf16 a[0:3], a[180:183], v[176:179], a[0:3]
    buffer_store_dwordx4 a[232:235], v235, s[16:19], s38 offen offset:2048 nt
    s_add_u32 s38, s38, 3072
    v_mfma_f32_16x16x32_bf16 a[4:7], a[180:183], v[184:187], a[4:7]
    v_exp_f32 v200, v52
    v_mfma_f32_16x16x32_bf16 a[8:11], a[180:183], v[192:195], a[8:11]
    v_cvt_pk_bf16_f32 v189, v204, v205
    s_waitcnt vmcnt(10) lgkmcnt(0)
    v_mfma_f32_16x16x32_bf16 a[12:15], a[180:183], v[196:199], a[12:15]
    s_barrier
    v_mfma_f32_16x16x32_bf16 a[16:19], a[184:187], v[176:179], a[16:19]
    ds_read_b128 a[200:203], v208
    v_fma_f32 v53, v53, s20, v223
    v_mfma_f32_16x16x32_bf16 a[20:23], a[184:187], v[184:187], a[20:23]
    s_add_u32 m0, s22, 135168
    v_fma_f32 v54, v54, s20, v223
    v_mfma_f32_16x16x32_bf16 a[244:247], a[252:255], v[192:195], a[244:247]
    v_exp_f32 v201, v53
    v_mfma_f32_16x16x32_bf16 a[24:27], a[184:187], v[192:195], a[24:27]
    buffer_load_dwordx4 v219, s[12:15], s26 offen nt lds
    v_mfma_f32_16x16x32_bf16 a[28:31], a[184:187], v[196:199], a[28:31]
    ds_read_b128 a[204:207], v209
    v_cvt_pk_bf16_f32 v190, v200, v201
    v_mfma_f32_16x16x32_bf16 a[32:35], a[188:191], v[176:179], a[32:35]
    v_exp_f32 v202, v54
    v_mfma_f32_16x16x32_bf16 a[36:39], a[188:191], v[184:187], a[36:39]
    ds_read_b128 a[208:211], v208 offset:128
    v_fma_f32 v55, v55, s20, v223
    v_mfma_f32_16x16x32_bf16 a[40:43], a[188:191], v[192:195], a[40:43]
    buffer_load_dwordx4 v220, s[12:15], s26 offen offset:1024 nt lds
    v_mfma_f32_16x16x32_bf16 a[44:47], a[188:191], v[196:199], a[44:47]
    ds_read_b128 a[212:215], v209 offset:128
    v_or_b32 v230, v180, v181
    v_mfma_f32_16x16x32_bf16 a[48:51], a[192:195], v[176:179], a[48:51]
    v_exp_f32 v203, v55
    v_mfma_f32_16x16x32_bf16 a[52:55], a[192:195], v[184:187], a[52:55]
    ds_read_b128 a[216:219], v208 offset:256
    v_cvt_pk_bf16_f32 v191, v202, v203
    v_mfma_f32_16x16x32_bf16 a[56:59], a[192:195], v[192:195], a[56:59]
    buffer_load_dwordx4 v221, s[12:15], s26 offen offset:2048 nt lds
    v_mfma_f32_16x16x32_bf16 a[60:63], a[192:195], v[196:199], a[60:63]
    ds_read_b128 a[220:223], v209 offset:256
    v_or3_b32 v230, v230, v182, v183
    v_mfma_f32_16x16x32_bf16 a[64:67], a[196:199], v[176:179], a[64:67]
    v_or3_b32 v230, v230, v188, v189
    v_or3_b32 v230, v230, v190, v191
    v_mfma_f32_16x16x32_bf16 a[68:71], a[196:199], v[184:187], a[68:71]
    v_fma_f32 v40, v40, s20, v224
    v_fma_f32 v41, v41, s20, v224
    v_mfma_f32_16x16x32_bf16 a[248:251], a[252:255], v[196:199], a[248:251]
    v_fma_f32 v42, v42, s20, v224
    v_fma_f32 v43, v43, s20, v224
    v_mfma_f32_16x16x32_bf16 a[72:75], a[196:199], v[192:195], a[72:75]
    s_add_u32 s26, s26, 12288
    v_mfma_f32_16x16x32_bf16 a[76:79], a[196:199], v[196:199], a[76:79]
    s_cmp_eq_u32 s30, 6
    s_cselect_b32 s25, s32, s25
    s_waitcnt lgkmcnt(0)
    v_mfma_f32_16x16x32_bf16 v[0:3], a[200:203], a[80:83], 0
    v_exp_f32 v200, v40
    v_mfma_f32_16x16x32_bf16 v[0:3], a[204:207], a[84:87], v[0:3]
    ds_read_b128 a[176:179], v208 offset:6144
    ds_read_b128 a[224:227], v237
    v_mfma_f32_16x16x32_bf16 v[0:3], a[208:211], a[88:91], v[0:3]
    ds_read_b128 a[228:231], v238
    v_fma_f32 v56, v56, s20, v224
    v_mfma_f32_16x16x32_bf16 v[0:3], a[212:215], a[92:95], v[0:3]
    ds_read_b128 a[180:183], v209 offset:6144
    v_add_u32 v237, 3072, v237
    v_mfma_f32_16x16x32_bf16 v[0:3], a[216:219], a[96:99], v[0:3]
    v_add_u32 v238, 3072, v238
    v_fma_f32 v57, v57, s20, v224
    v_mfma_f32_16x16x32_bf16 v[0:3], a[220:223], a[100:103], v[0:3]
    ds_read_b128 a[184:187], v208 offset:6272
    ds_read_b128 a[232:235], v239
    v_mfma_f32_16x16x32_bf16 v[4:7], a[200:203], a[104:107], 0
    v_exp_f32 v201, v41
    v_mfma_f32_16x16x32_bf16 v[4:7], a[204:207], a[108:111], v[4:7]
    ds_read_b128 a[188:191], v209 offset:6272
    v_add_u32 v239, 3072, v239
    v_mfma_f32_16x16x32_bf16 v[4:7], a[208:211], a[112:115], v[4:7]
    v_exp_f32 v202, v42
    v_mfma_f32_16x16x32_bf16 v[4:7], a[212:215], a[116:119], v[4:7]
    ds_read_b128 a[192:195], v208 offset:6400
    v_cvt_pk_bf16_f32 v192, v200, v201
    v_mfma_f32_16x16x32_bf16 v[4:7], a[216:219], a[120:123], v[4:7]
    v_exp_f32 v203, v43
    v_mfma_f32_16x16x32_bf16 v[4:7], a[220:223], a[124:127], v[4:7]
    ds_read_b128 a[196:199], v209 offset:6400
    v_exp_f32 v204, v56
    v_mfma_f32_16x16x32_bf16 v[8:11], a[200:203], a[128:131], 0
    v_exp_f32 v205, v57
    v_mfma_f32_16x16x32_bf16 v[8:11], a[204:207], a[132:135], v[8:11]
    v_cvt_pk_bf16_f32 v193, v202, v203
    v_cvt_pk_bf16_f32 v194, v204, v205
    v_mfma_f32_16x16x32_bf16 v[8:11], a[208:211], a[136:139], v[8:11]
    v_fma_f32 v58, v58, s20, v224
    v_fma_f32 v59, v59, s20, v224
    v_mfma_f32_16x16x32_bf16 v[8:11], a[212:215], a[140:143], v[8:11]
    v_exp_f32 v200, v58
    v_mfma_f32_16x16x32_bf16 v[8:11], a[216:219], a[144:147], v[8:11]
    v_exp_f32 v201, v59
    v_mfma_f32_16x16x32_bf16 v[8:11], a[220:223], a[148:151], v[8:11]
    s_mov_b32 m0, s28
    v_cvt_pk_bf16_f32 v195, v200, v201
    v_mfma_f32_16x16x32_bf16 v[12:15], a[200:203], a[152:155], 0
    s_waitcnt lgkmcnt(3)
    buffer_load_dwordx4 v216, s[4:7], s27 offen nt lds
    v_mfma_f32_16x16x32_bf16 v[12:15], a[204:207], a[156:159], v[12:15]
    v_fma_f32 v44, v44, s20, v225
    v_fma_f32 v45, v45, s20, v225
    v_mfma_f32_16x16x32_bf16 v[12:15], a[208:211], a[160:163], v[12:15]
    v_exp_f32 v202, v44
    v_mfma_f32_16x16x32_bf16 v[12:15], a[212:215], a[164:167], v[12:15]
    v_exp_f32 v203, v45
    v_mfma_f32_16x16x32_bf16 v[12:15], a[216:219], a[168:171], v[12:15]
    buffer_load_dwordx4 v217, s[4:7], s27 offen offset:1024 nt lds
    v_mfma_f32_16x16x32_bf16 v[12:15], a[220:223], a[172:175], v[12:15]
    v_cvt_pk_bf16_f32 v196, v202, v203
    v_fma_f32 v46, v46, s20, v225
    s_waitcnt lgkmcnt(0)
    v_mfma_f32_16x16x32_bf16 v[16:19], a[176:179], a[80:83], 0
    v_exp_f32 v204, v46
    v_mfma_f32_16x16x32_bf16 v[16:19], a[180:183], a[84:87], v[16:19]
    v_fma_f32 v47, v47, s20, v225
    v_fma_f32 v60, v60, s20, v225
    v_mfma_f32_16x16x32_bf16 v[16:19], a[184:187], a[88:91], v[16:19]
    buffer_load_dwordx4 v218, s[4:7], s27 offen offset:2048 nt lds
    v_mfma_f32_16x16x32_bf16 v[16:19], a[188:191], a[92:95], v[16:19]
    s_add_u32 s27, s27, 3072
    s_add_u32 s28, s28, 3072
    v_mfma_f32_16x16x32_bf16 v[16:19], a[192:195], a[96:99], v[16:19]
    v_exp_f32 v205, v47
    v_mfma_f32_16x16x32_bf16 v[16:19], a[196:199], a[100:103], v[16:19]
    v_exp_f32 v200, v60
    v_mfma_f32_16x16x32_bf16 v[20:23], a[176:179], a[104:107], 0
    v_cvt_pk_bf16_f32 v197, v204, v205
    s_waitcnt vmcnt(13) lgkmcnt(0)
    v_mfma_f32_16x16x32_bf16 v[20:23], a[180:183], a[108:111], v[20:23]
    s_barrier
    v_mfma_f32_16x16x32_bf16 v[20:23], a[184:187], a[112:115], v[20:23]
    ds_read_b64_tr_b16 a[200:201], v211 offset:12288
    v_fma_f32 v61, v61, s20, v225
    v_mfma_f32_16x16x32_bf16 v[20:23], a[188:191], a[116:119], v[20:23]
    ds_read_b64_tr_b16 a[202:203], v211 offset:18432
    s_add_u32 m0, s22, 98304
    v_mfma_f32_16x16x32_bf16 v[20:23], a[192:195], a[120:123], v[20:23]
    ds_read_b64_tr_b16 a[204:205], v211 offset:12296
    buffer_load_dwordx4 v216, s[8:11], s25 offen nt lds
    v_mfma_f32_16x16x32_bf16 v[20:23], a[196:199], a[124:127], v[20:23]
    ds_read_b64_tr_b16 a[206:207], v211 offset:18440
    v_exp_f32 v201, v61
    v_mfma_f32_16x16x32_bf16 v[24:27], a[176:179], a[128:131], 0
    ds_read_b64_tr_b16 a[208:209], v212 offset:12288
    v_cvt_pk_bf16_f32 v198, v200, v201
    v_mfma_f32_16x16x32_bf16 v[24:27], a[180:183], a[132:135], v[24:27]
    ds_read_b64_tr_b16 a[210:211], v212 offset:18432
    v_fma_f32 v62, v62, s20, v225
    v_mfma_f32_16x16x32_bf16 v[24:27], a[184:187], a[136:139], v[24:27]
    buffer_load_dwordx4 v217, s[8:11], s25 offen offset:1024 nt lds
    v_mfma_f32_16x16x32_bf16 v[24:27], a[188:191], a[140:143], v[24:27]
    v_exp_f32 v202, v62
    v_mfma_f32_16x16x32_bf16 v[24:27], a[192:195], a[144:147], v[24:27]
    ds_read_b64_tr_b16 a[212:213], v212 offset:12296
    v_fma_f32 v63, v63, s20, v225
    v_mfma_f32_16x16x32_bf16 v[24:27], a[196:199], a[148:151], v[24:27]
    ds_read_b64_tr_b16 a[214:215], v212 offset:18440
    v_or3_b32 v230, v230, v192, v193
    v_mfma_f32_16x16x32_bf16 v[28:31], a[176:179], a[152:155], 0
    buffer_load_dwordx4 v218, s[8:11], s25 offen offset:2048 nt lds
    v_mfma_f32_16x16x32_bf16 v[28:31], a[180:183], a[156:159], v[28:31]
    v_exp_f32 v203, v63
    v_mfma_f32_16x16x32_bf16 v[28:31], a[184:187], a[160:163], v[28:31]
    ds_read_b64_tr_b16 a[216:217], v211 offset:12416
    v_cvt_pk_bf16_f32 v199, v202, v203
    v_mfma_f32_16x16x32_bf16 v[28:31], a[188:191], a[164:167], v[28:31]
    ds_read_b64_tr_b16 a[218:219], v211 offset:18560
    v_or3_b32 v230, v230, v194, v195
    v_mfma_f32_16x16x32_bf16 v[28:31], a[192:195], a[168:171], v[28:31]
    s_add_u32 s25, s25, 12288
    v_or3_b32 v230, v230, v196, v197
    v_mfma_f32_16x16x32_bf16 v[28:31], a[196:199], a[172:175], v[28:31]
    v_or3_b32 v230, v230, v198, v199
    v_and_b32 v230, 0x40004000, v230
    v_cmp_ne_u32 vcc, 0, v230
    s_cbranch_vccnz L_rare_sto
L_ret_sto:
    s_waitcnt lgkmcnt(6)
    v_mfma_f32_16x16x32_bf16 v[64:67], a[200:203], v[180:183], v[64:67]
    ds_read_b64_tr_b16 a[220:221], v211 offset:12424
    v_fma_f32 v0, v0, s20, v222
    v_mfma_f32_16x16x32_bf16 v[68:71], a[200:203], v[188:191], v[68:71]
    ds_read_b64_tr_b16 a[222:223], v211 offset:18568
    v_fma_f32 v1, v1, s20, v222
    v_mfma_f32_16x16x32_bf16 v[72:75], a[200:203], v[192:195], v[72:75]
    v_exp_f32 v200, v0
    v_mfma_f32_16x16x32_bf16 v[76:79], a[200:203], v[196:199], v[76:79]
    ds_read_b64_tr_b16 a[200:201], v212 offset:12416
    v_fma_f32 v2, v2, s20, v222
    v_mfma_f32_16x16x32_bf16 v[80:83], a[204:207], v[180:183], v[80:83]
    ds_read_b64_tr_b16 a[202:203], v212 offset:18560
    v_fma_f32 v3, v3, s20, v222
    v_mfma_f32_16x16x32_bf16 v[84:87], a[204:207], v[188:191], v[84:87]
    v_exp_f32 v201, v1
    v_mfma_f32_16x16x32_bf16 v[88:91], a[204:207], v[192:195], v[88:91]
    v_exp_f32 v202, v2
    v_mfma_f32_16x16x32_bf16 v[92:95], a[204:207], v[196:199], v[92:95]
    ds_read_b64_tr_b16 a[204:205], v212 offset:12424
    s_waitcnt lgkmcnt(7)
    v_mfma_f32_16x16x32_bf16 v[96:99], a[208:211], v[180:183], v[96:99]
    ds_read_b64_tr_b16 a[206:207], v212 offset:18568
    v_cvt_pk_bf16_f32 v176, v200, v201
    v_mfma_f32_16x16x32_bf16 v[100:103], a[208:211], v[188:191], v[100:103]
    v_exp_f32 v203, v3
    v_mfma_f32_16x16x32_bf16 a[236:239], a[252:255], v[180:183], a[236:239]
    v_cvt_pk_bf16_f32 v177, v202, v203
    v_fma_f32 v16, v16, s20, v222
    v_mfma_f32_16x16x32_bf16 v[104:107], a[208:211], v[192:195], v[104:107]
    v_exp_f32 v204, v16
    v_mfma_f32_16x16x32_bf16 v[108:111], a[208:211], v[196:199], v[108:111]
    ds_read_b64_tr_b16 a[208:209], v211 offset:12544
    v_fma_f32 v17, v17, s20, v222
    v_mfma_f32_16x16x32_bf16 v[112:115], a[212:215], v[180:183], v[112:115]
    ds_read_b64_tr_b16 a[210:211], v211 offset:18688
    v_fma_f32 v18, v18, s20, v222
    v_mfma_f32_16x16x32_bf16 v[116:119], a[212:215], v[188:191], v[116:119]
    v_exp_f32 v205, v17
    v_mfma_f32_16x16x32_bf16 v[120:123], a[212:215], v[192:195], v[120:123]
    v_exp_f32 v200, v18
    v_mfma_f32_16x16x32_bf16 v[124:127], a[212:215], v[196:199], v[124:127]
    ds_read_b64_tr_b16 a[212:213], v211 offset:12552
    s_waitcnt lgkmcnt(7)
    v_mfma_f32_16x16x32_bf16 v[128:131], a[216:219], v[180:183], v[128:131]
    ds_read_b64_tr_b16 a[214:215], v211 offset:18696
    v_cvt_pk_bf16_f32 v178, v204, v205
    v_mfma_f32_16x16x32_bf16 v[132:135], a[216:219], v[188:191], v[132:135]
    v_fma_f32 v19, v19, s20, v222
    v_fma_f32 v4, v4, s20, v223
    v_mfma_f32_16x16x32_bf16 v[136:139], a[216:219], v[192:195], v[136:139]
    v_exp_f32 v201, v19
    v_mfma_f32_16x16x32_bf16 v[140:143], a[216:219], v[196:199], v[140:143]
    ds_read_b64_tr_b16 a[216:217], v212 offset:12544
    v_cvt_pk_bf16_f32 v179, v200, v201
    v_mfma_f32_16x16x32_bf16 v[144:147], a[220:223], v[180:183], v[144:147]
    ds_read_b64_tr_b16 a[218:219], v212 offset:18688
    v_fma_f32 v5, v5, s20, v223
    v_mfma_f32_16x16x32_bf16 v[148:151], a[220:223], v[188:191], v[148:151]
    v_exp_f32 v202, v4
    v_mfma_f32_16x16x32_bf16 a[240:243], a[252:255], v[188:191], a[240:243]
    v_exp_f32 v203, v5
    v_mfma_f32_16x16x32_bf16 v[152:155], a[220:223], v[192:195], v[152:155]
    v_cvt_pk_bf16_f32 v184, v202, v203
    v_fma_f32 v6, v6, s20, v223
    v_mfma_f32_16x16x32_bf16 v[156:159], a[220:223], v[196:199], v[156:159]
    ds_read_b64_tr_b16 a[220:221], v212 offset:12552
    s_waitcnt lgkmcnt(7)
    v_mfma_f32_16x16x32_bf16 v[160:163], a[200:203], v[180:183], v[160:163]
    ds_read_b64_tr_b16 a[222:223], v212 offset:18696
    v_fma_f32 v7, v7, s20, v223
    v_mfma_f32_16x16x32_bf16 v[164:167], a[200:203], v[188:191], v[164:167]
    v_exp_f32 v204, v6
    v_mfma_f32_16x16x32_bf16 v[168:171], a[200:203], v[192:195], v[168:171]
    v_exp_f32 v205, v7
    v_mfma_f32_16x16x32_bf16 v[172:175], a[200:203], v[196:199], v[172:175]
    v_cvt_pk_bf16_f32 v185, v204, v205
    v_fma_f32 v20, v20, s20, v223
    v_mfma_f32_16x16x32_bf16 a[0:3], a[204:207], v[180:183], a[0:3]
    v_exp_f32 v200, v20
    v_mfma_f32_16x16x32_bf16 a[4:7], a[204:207], v[188:191], a[4:7]
    v_fma_f32 v21, v21, s20, v223
    v_fma_f32 v22, v22, s20, v223
    v_mfma_f32_16x16x32_bf16 a[8:11], a[204:207], v[192:195], a[8:11]
    v_fma_f32 v23, v23, s20, v223
    s_waitcnt vmcnt(11) lgkmcnt(0)
    v_mfma_f32_16x16x32_bf16 a[12:15], a[204:207], v[196:199], a[12:15]
    s_barrier
    v_mfma_f32_16x16x32_bf16 a[16:19], a[208:211], v[180:183], a[16:19]
    ds_read_b128 a[176:179], v208 offset:24576
    v_or_b32 v230, v176, v177
    v_mfma_f32_16x16x32_bf16 a[20:23], a[208:211], v[188:191], a[20:23]
    s_add_u32 m0, s22, 110592
    v_or3_b32 v230, v230, v178, v179
    v_mfma_f32_16x16x32_bf16 a[244:247], a[252:255], v[192:195], a[244:247]
    v_exp_f32 v201, v21
    v_mfma_f32_16x16x32_bf16 a[24:27], a[208:211], v[192:195], a[24:27]
    buffer_load_dwordx4 v219, s[12:15], s26 offen nt lds
    v_mfma_f32_16x16x32_bf16 a[28:31], a[208:211], v[196:199], a[28:31]
    ds_read_b128 a[180:183], v209 offset:24576
    v_cvt_pk_bf16_f32 v186, v200, v201
    v_mfma_f32_16x16x32_bf16 a[32:35], a[212:215], v[180:183], a[32:35]
    v_exp_f32 v202, v22
    v_mfma_f32_16x16x32_bf16 a[36:39], a[212:215], v[188:191], a[36:39]
    ds_read_b128 a[184:187], v208 offset:24704
    v_or3_b32 v230, v230, v184, v185
    v_mfma_f32_16x16x32_bf16 a[40:43], a[212:215], v[192:195], a[40:43]
    buffer_load_dwordx4 v220, s[12:15], s26 offen offset:1024 nt lds
    v_mfma_f32_16x16x32_bf16 a[44:47], a[212:215], v[196:199], a[44:47]
    ds_read_b128 a[188:191], v209 offset:24704
    v_fma_f32 v8, v8, s20, v224
    v_mfma_f32_16x16x32_bf16 a[48:51], a[216:219], v[180:183], a[48:51]
    v_exp_f32 v203, v23
    v_mfma_f32_16x16x32_bf16 a[52:55], a[216:219], v[188:191], a[52:55]
    ds_read_b128 a[192:195], v208 offset:24832
    v_cvt_pk_bf16_f32 v187, v202, v203
    v_mfma_f32_16x16x32_bf16 a[56:59], a[216:219], v[192:195], a[56:59]
    buffer_load_dwordx4 v221, s[12:15], s26 offen offset:2048 nt lds
    v_mfma_f32_16x16x32_bf16 a[60:63], a[216:219], v[196:199], a[60:63]
    ds_read_b128 a[196:199], v209 offset:24832
    v_or3_b32 v230, v230, v186, v187
    v_mfma_f32_16x16x32_bf16 a[64:67], a[220:223], v[180:183], a[64:67]
    v_fma_f32 v9, v9, s20, v224
    v_fma_f32 v10, v10, s20, v224
    v_mfma_f32_16x16x32_bf16 a[68:71], a[220:223], v[188:191], a[68:71]
    v_fma_f32 v11, v11, s20, v224
    v_mfma_f32_16x16x32_bf16 a[248:251], a[252:255], v[196:199], a[248:251]
    v_mfma_f32_16x16x32_bf16 a[72:75], a[220:223], v[192:195], a[72:75]
    s_add_u32 s26, s26, 12288
    v_mfma_f32_16x16x32_bf16 a[76:79], a[220:223], v[196:199], a[76:79]
    s_add_u32 s30, s30, 1
    s_cmp_lt_u32 s30, 7
    s_cbranch_scc1 L_steady
    s_cmp_eq_u32 s31, 3
    s_cbranch_scc1 L_last
    s_mov_b32 s26, s32
    s_waitcnt lgkmcnt(0)
    v_mfma_f32_16x16x32_bf16 v[32:35], a[176:179], a[80:83], 0
    v_exp_f32 v200, v8
    v_mfma_f32_16x16x32_bf16 v[32:35], a[180:183], a[84:87], v[32:35]
    ds_read_b128 a[200:203], v208 offset:30720
    v_fma_f32 v24, v24, s20, v224
    v_mfma_f32_16x16x32_bf16 v[32:35], a[184:187], a[88:91], v[32:35]
    v_exp_f32 v201, v9
    v_mfma_f32_16x16x32_bf16 v[32:35], a[188:191], a[92:95], v[32:35]
    ds_read_b128 a[204:207], v209 offset:30720
    v_cvt_pk_bf16_f32 v192, v200, v201
    v_mfma_f32_16x16x32_bf16 v[32:35], a[192:195], a[96:99], v[32:35]
    v_exp_f32 v202, v10
    v_mfma_f32_16x16x32_bf16 v[32:35], a[196:199], a[100:103], v[32:35]
    ds_read_b128 a[208:211], v208 offset:30848
    v_fma_f32 v25, v25, s20, v224
    v_mfma_f32_16x16x32_bf16 v[36:39], a[176:179], a[104:107], 0
    v_exp_f32 v203, v11
    v_mfma_f32_16x16x32_bf16 v[36:39], a[180:183], a[108:111], v[36:39]
    ds_read_b128 a[212:215], v209 offset:30848
    v_cvt_pk_bf16_f32 v193, v202, v203
    v_mfma_f32_16x16x32_bf16 v[36:39], a[184:187], a[112:115], v[36:39]
    v_exp_f32 v204, v24
    v_mfma_f32_16x16x32_bf16 v[36:39], a[188:191], a[116:119], v[36:39]
    ds_read_b128 a[216:219], v208 offset:30976
    v_fma_f32 v26, v26, s20, v224
    v_mfma_f32_16x16x32_bf16 v[36:39], a[192:195], a[120:123], v[36:39]
    v_exp_f32 v205, v25
    v_mfma_f32_16x16x32_bf16 v[36:39], a[196:199], a[124:127], v[36:39]
    ds_read_b128 a[220:223], v209 offset:30976
    v_cvt_pk_bf16_f32 v194, v204, v205
    v_mfma_f32_16x16x32_bf16 v[40:43], a[176:179], a[128:131], 0
    buffer_store_dwordx4 a[224:227], v235, s[16:19], s38 offen nt
    v_mfma_f32_16x16x32_bf16 v[40:43], a[180:183], a[132:135], v[40:43]
    v_exp_f32 v200, v26
    v_mfma_f32_16x16x32_bf16 v[40:43], a[184:187], a[136:139], v[40:43]
    v_fma_f32 v27, v27, s20, v224
    v_fma_f32 v12, v12, s20, v225
    v_mfma_f32_16x16x32_bf16 v[40:43], a[188:191], a[140:143], v[40:43]
    v_exp_f32 v201, v27
    v_mfma_f32_16x16x32_bf16 v[40:43], a[192:195], a[144:147], v[40:43]
    v_exp_f32 v202, v12
    v_mfma_f32_16x16x32_bf16 v[40:43], a[196:199], a[148:151], v[40:43]
    v_cvt_pk_bf16_f32 v195, v200, v201
    v_fma_f32 v13, v13, s20, v225
    v_mfma_f32_16x16x32_bf16 v[44:47], a[176:179], a[152:155], 0
    v_exp_f32 v203, v13
    v_mfma_f32_16x16x32_bf16 v[44:47], a[180:183], a[156:159], v[44:47]
    v_cvt_pk_bf16_f32 v196, v202, v203
    v_fma_f32 v14, v14, s20, v225
    v_mfma_f32_16x16x32_bf16 v[44:47], a[184:187], a[160:163], v[44:47]
    v_exp_f32 v204, v14
    v_mfma_f32_16x16x32_bf16 v[44:47], a[188:191], a[164:167], v[44:47]
    v_fma_f32 v15, v15, s20, v225
    v_fma_f32 v28, v28, s20, v225
    v_mfma_f32_16x16x32_bf16 v[44:47], a[192:195], a[168:171], v[44:47]
    v_exp_f32 v205, v15
    v_mfma_f32_16x16x32_bf16 v[44:47], a[196:199], a[172:175], v[44:47]
    v_cvt_pk_bf16_f32 v197, v204, v205
    s_waitcnt lgkmcnt(0)
    v_mfma_f32_16x16x32_bf16 v[48:51], a[200:203], a[80:83], 0
    v_exp_f32 v200, v28
    v_mfma_f32_16x16x32_bf16 v[48:51], a[204:207], a[84:87], v[48:51]
    v_fma_f32 v29, v29, s20, v225
    v_fma_f32 v30, v30, s20, v225
    v_mfma_f32_16x16x32_bf16 v[48:51], a[208:211], a[88:91], v[48:51]
    v_exp_f32 v201, v29
    v_mfma_f32_16x16x32_bf16 v[48:51], a[212:215], a[92:95], v[48:51]
    v_exp_f32 v202, v30
    v_mfma_f32_16x16x32_bf16 v[48:51], a[216:219], a[96:99], v[48:51]
    v_cvt_pk_bf16_f32 v198, v200, v201
    v_fma_f32 v31, v31, s20, v225
    v_mfma_f32_16x16x32_bf16 v[48:51], a[220:223], a[100:103], v[48:51]
    v_exp_f32 v203, v31
    v_mfma_f32_16x16x32_bf16 v[52:55], a[200:203], a[104:107], 0
    v_cvt_pk_bf16_f32 v199, v202, v203
    s_waitcnt vmcnt(10) lgkmcnt(0)
    v_mfma_f32_16x16x32_bf16 v[52:55], a[204:207], a[108:111], v[52:55]
    s_barrier
    v_mfma_f32_16x16x32_bf16 v[52:55], a[208:211], a[112:115], v[52:55]
    ds_read_b64_tr_b16 a[176:177], v211 offset:36864
    v_or3_b32 v230, v230, v192, v193
    v_mfma_f32_16x16x32_bf16 v[52:55], a[212:215], a[116:119], v[52:55]
    ds_read_b64_tr_b16 a[178:179], v211 offset:43008
    s_add_u32 m0, s22, 122880
    v_mfma_f32_16x16x32_bf16 v[52:55], a[216:219], a[120:123], v[52:55]
    ds_read_b64_tr_b16 a[180:181], v211 offset:36872
    buffer_load_dwordx4 v216, s[8:11], s25 offen nt lds
    v_mfma_f32_16x16x32_bf16 v[52:55], a[220:223], a[124:127], v[52:55]
    ds_read_b64_tr_b16 a[182:183], v211 offset:43016
    v_or3_b32 v230, v230, v194, v195
    v_mfma_f32_16x16x32_bf16 v[56:59], a[200:203], a[128:131], 0
    ds_read_b64_tr_b16 a[184:185], v212 offset:36864
    v_or3_b32 v230, v230, v196, v197
    v_mfma_f32_16x16x32_bf16 v[56:59], a[204:207], a[132:135], v[56:59]
    ds_read_b64_tr_b16 a[186:187], v212 offset:43008
    v_or3_b32 v230, v230, v198, v199
    v_mfma_f32_16x16x32_bf16 v[56:59], a[208:211], a[136:139], v[56:59]
    buffer_load_dwordx4 v217, s[8:11], s25 offen offset:1024 nt lds
    v_mfma_f32_16x16x32_bf16 v[56:59], a[212:215], a[140:143], v[56:59]
    v_and_b32 v230, 0x40004000, v230
    v_cmp_ne_u32 vcc, 0, v230
    v_mfma_f32_16x16x32_bf16 v[56:59], a[216:219], a[144:147], v[56:59]
    ds_read_b64_tr_b16 a[188:189], v212 offset:36872
    v_mfma_f32_16x16x32_bf16 v[56:59], a[220:223], a[148:151], v[56:59]
    ds_read_b64_tr_b16 a[190:191], v212 offset:43016
    v_mfma_f32_16x16x32_bf16 v[60:63], a[200:203], a[152:155], 0
    buffer_load_dwordx4 v218, s[8:11], s25 offen offset:2048 nt lds
    v_mfma_f32_16x16x32_bf16 v[60:63], a[204:207], a[156:159], v[60:63]
    v_mfma_f32_16x16x32_bf16 v[60:63], a[208:211], a[160:163], v[60:63]
    ds_read_b64_tr_b16 a[192:193], v211 offset:36992
    v_mfma_f32_16x16x32_bf16 v[60:63], a[212:215], a[164:167], v[60:63]
    ds_read_b64_tr_b16 a[194:195], v211 offset:43136
    v_mfma_f32_16x16x32_bf16 v[60:63], a[216:219], a[168:171], v[60:63]
    s_add_u32 s25, s25, 12288
    v_mfma_f32_16x16x32_bf16 v[60:63], a[220:223], a[172:175], v[60:63]
    s_cbranch_vccnz L_rare_b7e
L_ret_b7e:
    v_mov_b32 v244, v234
    v_xor_b32 v245, 64, v234
    s_waitcnt vmcnt(10)
    s_waitcnt lgkmcnt(6)
    v_mfma_f32_16x16x32_bf16 v[64:67], a[176:179], v[176:179], v[64:67]
    ds_read_b64_tr_b16 a[196:197], v211 offset:37000
    ds_read_b128 a[80:83], v244
    v_mfma_f32_16x16x32_bf16 v[68:71], a[176:179], v[184:187], v[68:71]
    ds_read_b64_tr_b16 a[198:199], v211 offset:43144
    v_fma_f32 v32, v32, s20, v222
    v_mfma_f32_16x16x32_bf16 v[72:75], a[176:179], v[192:195], v[72:75]
    ds_read_b128 a[84:87], v245
    v_fma_f32 v33, v33, s20, v222
    v_mfma_f32_16x16x32_bf16 v[76:79], a[176:179], v[196:199], v[76:79]
    ds_read_b64_tr_b16 a[176:177], v212 offset:36992
    v_exp_f32 v200, v32
    v_mfma_f32_16x16x32_bf16 v[80:83], a[180:183], v[176:179], v[80:83]
    ds_read_b64_tr_b16 a[178:179], v212 offset:43136
    ds_read_b128 a[88:91], v244 offset:128
    v_mfma_f32_16x16x32_bf16 v[84:87], a[180:183], v[184:187], v[84:87]
    v_exp_f32 v201, v33
    v_mfma_f32_16x16x32_bf16 v[88:91], a[180:183], v[192:195], v[88:91]
    ds_read_b128 a[92:95], v245 offset:128
    v_cvt_pk_bf16_f32 v180, v200, v201
    v_fma_f32 v34, v34, s20, v222
    v_mfma_f32_16x16x32_bf16 v[92:95], a[180:183], v[196:199], v[92:95]
    ds_read_b64_tr_b16 a[180:181], v212 offset:37000
    s_waitcnt lgkmcnt(11)
    v_mfma_f32_16x16x32_bf16 v[96:99], a[184:187], v[176:179], v[96:99]
    ds_read_b64_tr_b16 a[182:183], v212 offset:43144
    ds_read_b128 a[96:99], v244 offset:256
    v_mfma_f32_16x16x32_bf16 v[100:103], a[184:187], v[184:187], v[100:103]
    v_exp_f32 v202, v34
    v_fma_f32 v35, v35, s20, v222
    v_mfma_f32_16x16x32_bf16 a[236:239], a[252:255], v[176:179], a[236:239]
    v_exp_f32 v203, v35
    v_mfma_f32_16x16x32_bf16 v[104:107], a[184:187], v[192:195], v[104:107]
    ds_read_b128 a[100:103], v245 offset:256
    v_cvt_pk_bf16_f32 v181, v202, v203
    v_mfma_f32_16x16x32_bf16 v[108:111], a[184:187], v[196:199], v[108:111]
    ds_read_b64_tr_b16 a[184:185], v211 offset:37120
    v_fma_f32 v48, v48, s20, v222
    v_fma_f32 v49, v49, s20, v222
    v_mfma_f32_16x16x32_bf16 v[112:115], a[188:191], v[176:179], v[112:115]
    ds_read_b64_tr_b16 a[186:187], v211 offset:43264
    ds_read_b128 a[104:107], v244 offset:6144
    buffer_store_dwordx4 a[228:231], v235, s[16:19], s38 offen offset:1024 nt
    v_mfma_f32_16x16x32_bf16 v[116:119], a[188:191], v[184:187], v[116:119]
    v_exp_f32 v204, v48
    v_mfma_f32_16x16x32_bf16 v[120:123], a[188:191], v[192:195], v[120:123]
    ds_read_b128 a[108:111], v245 offset:6144
    v_fma_f32 v50, v50, s20, v222
    v_mfma_f32_16x16x32_bf16 v[124:127], a[188:191], v[196:199], v[124:127]
    ds_read_b64_tr_b16 a[188:189], v211 offset:37128
    v_fma_f32 v51, v51, s20, v222
    s_waitcnt lgkmcnt(14)
    v_mfma_f32_16x16x32_bf16 v[128:131], a[192:195], v[176:179], v[128:131]
    ds_read_b64_tr_b16 a[190:191], v211 offset:43272
    ds_read_b128 a[112:115], v244 offset:6272
    v_mfma_f32_16x16x32_bf16 v[132:135], a[192:195], v[184:187], v[132:135]
    v_exp_f32 v205, v49
    v_mfma_f32_16x16x32_bf16 v[136:139], a[192:195], v[192:195], v[136:139]
    ds_read_b128 a[116:119], v245 offset:6272
    v_exp_f32 v200, v50
    v_mfma_f32_16x16x32_bf16 v[140:143], a[192:195], v[196:199], v[140:143]
    ds_read_b64_tr_b16 a[192:193], v212 offset:37120
    v_cvt_pk_bf16_f32 v182, v204, v205
    v_mfma_f32_16x16x32_bf16 v[144:147], a[196:199], v[176:179], v[144:147]
    ds_read_b64_tr_b16 a[194:195], v212 offset:43264
    ds_read_b128 a[120:123], v244 offset:6400
    v_mfma_f32_16x16x32_bf16 v[148:151], a[196:199], v[184:187], v[148:151]
    v_exp_f32 v201, v51
    v_fma_f32 v36, v36, s20, v223
    v_mfma_f32_16x16x32_bf16 a[240:243], a[252:255], v[184:187], a[240:243]
    v_exp_f32 v202, v36
    v_mfma_f32_16x16x32_bf16 v[152:155], a[196:199], v[192:195], v[152:155]
    ds_read_b128 a[124:127], v245 offset:6400
    v_cvt_pk_bf16_f32 v183, v200, v201
    v_mfma_f32_16x16x32_bf16 v[156:159], a[196:199], v[196:199], v[156:159]
    ds_read_b64_tr_b16 a[196:197], v212 offset:37128
    v_fma_f32 v37, v37, s20, v223
    s_waitcnt lgkmcnt(14)
    v_mfma_f32_16x16x32_bf16 v[160:163], a[176:179], v[176:179], v[160:163]
    ds_read_b64_tr_b16 a[198:199], v212 offset:43272
    ds_read_b128 a[128:131], v244 offset:12288
    v_mfma_f32_16x16x32_bf16 v[164:167], a[176:179], v[184:187], v[164:167]
    v_exp_f32 v203, v37
    v_mfma_f32_16x16x32_bf16 v[168:171], a[176:179], v[192:195], v[168:171]
    ds_read_b128 a[132:135], v245 offset:12288
    v_cvt_pk_bf16_f32 v188, v202, v203
    v_mfma_f32_16x16x32_bf16 v[172:175], a[176:179], v[196:199], v[172:175]
    v_fma_f32 v38, v38, s20, v223
    v_exp_f32 v204, v38
    v_mfma_f32_16x16x32_bf16 a[0:3], a[180:183], v[176:179], a[0:3]
    ds_read_b128 a[136:139], v244 offset:12416
    buffer_store_dwordx4 a[232:235], v235, s[16:19], s38 offen offset:2048 nt
    s_add_u32 s38, s38, 3072
    v_mfma_f32_16x16x32_bf16 a[4:7], a[180:183], v[184:187], a[4:7]
    v_fma_f32 v39, v39, s20, v223
    v_fma_f32 v52, v52, s20, v223
    v_mfma_f32_16x16x32_bf16 a[8:11], a[180:183], v[192:195], a[8:11]
    ds_read_b128 a[140:143], v245 offset:12416
    v_fma_f32 v53, v53, s20, v223
    s_waitcnt vmcnt(9) lgkmcnt(0)
    v_mfma_f32_16x16x32_bf16 a[12:15], a[180:183], v[196:199], a[12:15]
    s_barrier
    v_mfma_f32_16x16x32_bf16 a[16:19], a[184:187], v[176:179], a[16:19]
    ds_read_b128 a[200:203], v208
    ds_read_b128 a[144:147], v244 offset:12544
    v_mfma_f32_16x16x32_bf16 a[20:23], a[184:187], v[184:187], a[20:23]
    s_add_u32 m0, s22, 135168
    v_exp_f32 v205, v39
    v_mfma_f32_16x16x32_bf16 a[244:247], a[252:255], v[192:195], a[244:247]
    v_exp_f32 v200, v52
    v_mfma_f32_16x16x32_bf16 a[24:27], a[184:187], v[192:195], a[24:27]
    ds_read_b128 a[148:151], v245 offset:12544
    buffer_load_dwordx4 v219, s[12:15], s26 offen nt lds
    v_mfma_f32_16x16x32_bf16 a[28:31], a[184:187], v[196:199], a[28:31]
    ds_read_b128 a[204:207], v209
    v_exp_f32 v201, v53
    v_mfma_f32_16x16x32_bf16 a[32:35], a[188:191], v[176:179], a[32:35]
    ds_read_b128 a[152:155], v244 offset:18432
    v_cvt_pk_bf16_f32 v189, v204, v205
    v_mfma_f32_16x16x32_bf16 a[36:39], a[188:191], v[184:187], a[36:39]
    ds_read_b128 a[208:211], v208 offset:128
    v_cvt_pk_bf16_f32 v190, v200, v201
    v_mfma_f32_16x16x32_bf16 a[40:43], a[188:191], v[192:195], a[40:43]
    ds_read_b128 a[156:159], v245 offset:18432
    buffer_load_dwordx4 v220, s[12:15], s26 offen offset:1024 nt lds
    v_mfma_f32_16x16x32_bf16 a[44:47], a[188:191], v[196:199], a[44:47]
    ds_read_b128 a[212:215], v209 offset:128
    v_fma_f32 v54, v54, s20, v223
    v_fma_f32 v55, v55, s20, v223
    v_mfma_f32_16x16x32_bf16 a[48:51], a[192:195], v[176:179], a[48:51]
    ds_read_b128 a[160:163], v244 offset:18560
    v_or_b32 v230, v180, v181
    v_mfma_f32_16x16x32_bf16 a[52:55], a[192:195], v[184:187], a[52:55]
    ds_read_b128 a[216:219], v208 offset:256
    v_or3_b32 v230, v230, v182, v183
    v_mfma_f32_16x16x32_bf16 a[56:59], a[192:195], v[192:195], a[56:59]
    ds_read_b128 a[164:167], v245 offset:18560
    buffer_load_dwordx4 v221, s[12:15], s26 offen offset:2048 nt lds
    v_or3_b32 v230, v230, v188, v189
    v_mfma_f32_16x16x32_bf16 a[60:63], a[192:195], v[196:199], a[60:63]
    ds_read_b128 a[220:223], v209 offset:256
    v_fma_f32 v40, v40, s20, v224
    v_mfma_f32_16x16x32_bf16 a[64:67], a[196:199], v[176:179], a[64:67]
    ds_read_b128 a[168:171], v244 offset:18688
    v_fma_f32 v41, v41, s20, v224
    v_mfma_f32_16x16x32_bf16 a[68:71], a[196:199], v[184:187], a[68:71]
    v_exp_f32 v202, v54
    v_fma_f32 v42, v42, s20, v224
    v_mfma_f32_16x16x32_bf16 a[248:251], a[252:255], v[196:199], a[248:251]
    v_exp_f32 v203, v55
    v_mfma_f32_16x16x32_bf16 a[72:75], a[196:199], v[192:195], a[72:75]
    ds_read_b128 a[172:175], v245 offset:18688
    s_add_u32 s26, s26, 12288
    v_mfma_f32_16x16x32_bf16 a[76:79], a[196:199], v[196:199], a[76:79]
    v_cvt_pk_bf16_f32 v191, v202, v203
    v_or3_b32 v230, v230, v190, v191
    v_fma_f32 v43, v43, s20, v224
    s_waitcnt lgkmcnt(0)
    v_mfma_f32_16x16x32_bf16 v[0:3], a[200:203], a[80:83], 0
    v_exp_f32 v200, v40
    v_mfma_f32_16x16x32_bf16 v[0:3], a[204:207], a[84:87], v[0:3]
    ds_read_b128 a[176:179], v208 offset:6144
    v_fma_f32 v56, v56, s20, v224
    v_mfma_f32_16x16x32_bf16 v[0:3], a[208:211], a[88:91], v[0:3]
    v_exp_f32 v201, v41
    v_mfma_f32_16x16x32_bf16 v[0:3], a[212:215], a[92:95], v[0:3]
    ds_read_b128 a[180:183], v209 offset:6144
    v_cvt_pk_bf16_f32 v192, v200, v201
    v_mfma_f32_16x16x32_bf16 v[0:3], a[216:219], a[96:99], v[0:3]
    v_exp_f32 v202, v42
    v_mfma_f32_16x16x32_bf16 v[0:3], a[220:223], a[100:103], v[0:3]
    ds_read_b128 a[184:187], v208 offset:6272
    v_fma_f32 v57, v57, s20, v224
    v_mfma_f32_16x16x32_bf16 v[4:7], a[200:203], a[104:107], 0
    v_exp_f32 v203, v43
    v_mfma_f32_16x16x32_bf16 v[4:7], a[204:207], a[108:111], v[4:7]
    ds_read_b128 a[188:191], v209 offset:6272
    v_cvt_pk_bf16_f32 v193, v202, v203
    v_mfma_f32_16x16x32_bf16 v[4:7], a[208:211], a[112:115], v[4:7]
    v_exp_f32 v204, v56
    v_mfma_f32_16x16x32_bf16 v[4:7], a[212:215], a[116:119], v[4:7]
    ds_read_b128 a[192:195], v208 offset:6400
    v_fma_f32 v58, v58, s20, v224
    v_mfma_f32_16x16x32_bf16 v[4:7], a[216:219], a[120:123], v[4:7]
    v_exp_f32 v205, v57
    v_mfma_f32_16x16x32_bf16 v[4:7], a[220:223], a[124:127], v[4:7]
    ds_read_b128 a[196:199], v209 offset:6400
    v_cvt_pk_bf16_f32 v194, v204, v205
    v_mfma_f32_16x16x32_bf16 v[8:11], a[200:203], a[128:131], 0
    v_exp_f32 v200, v58
    v_mfma_f32_16x16x32_bf16 v[8:11], a[204:207], a[132:135], v[8:11]
    v_fma_f32 v59, v59, s20, v224
    v_fma_f32 v44, v44, s20, v225
    v_mfma_f32_16x16x32_bf16 v[8:11], a[208:211], a[136:139], v[8:11]
    v_exp_f32 v201, v59
    v_mfma_f32_16x16x32_bf16 v[8:11], a[212:215], a[140:143], v[8:11]
    v_exp_f32 v202, v44
    v_mfma_f32_16x16x32_bf16 v[8:11], a[216:219], a[144:147], v[8:11]
    v_cvt_pk_bf16_f32 v195, v200, v201
    v_fma_f32 v45, v45, s20, v225
    v_mfma_f32_16x16x32_bf16 v[8:11], a[220:223], a[148:151], v[8:11]
    v_exp_f32 v203, v45
    v_mfma_f32_16x16x32_bf16 v[12:15], a[200:203], a[152:155], 0
    v_cvt_pk_bf16_f32 v196, v202, v203
    v_fma_f32 v46, v46, s20, v225
    v_mfma_f32_16x16x32_bf16 v[12:15], a[204:207], a[156:159], v[12:15]
    v_exp_f32 v204, v46
    v_mfma_f32_16x16x32_bf16 v[12:15], a[208:211], a[160:163], v[12:15]
    v_fma_f32 v47, v47, s20, v225
    v_fma_f32 v60, v60, s20, v225
    v_mfma_f32_16x16x32_bf16 v[12:15], a[212:215], a[164:167], v[12:15]
    v_exp_f32 v205, v47
    v_mfma_f32_16x16x32_bf16 v[12:15], a[216:219], a[168:171], v[12:15]
    v_exp_f32 v200, v60
    v_mfma_f32_16x16x32_bf16 v[12:15], a[220:223], a[172:175], v[12:15]
    v_cvt_pk_bf16_f32 v197, v204, v205
    s_waitcnt lgkmcnt(0)
    v_mfma_f32_16x16x32_bf16 v[16:19], a[176:179], a[80:83], 0
    v_fma_f32 v61, v61, s20, v225
    v_fma_f32 v62, v62, s20, v225
    v_mfma_f32_16x16x32_bf16 v[16:19], a[180:183], a[84:87], v[16:19]
    v_exp_f32 v201, v61
    v_mfma_f32_16x16x32_bf16 v[16:19], a[184:187], a[88:91], v[16:19]
    v_exp_f32 v202, v62
    v_mfma_f32_16x16x32_bf16 v[16:19], a[188:191], a[92:95], v[16:19]
    v_cvt_pk_bf16_f32 v198, v200, v201
    v_fma_f32 v63, v63, s20, v225
    v_mfma_f32_16x16x32_bf16 v[16:19], a[192:195], a[96:99], v[16:19]
    v_exp_f32 v203, v63
    v_mfma_f32_16x16x32_bf16 v[16:19], a[196:199], a[100:103], v[16:19]
    v_cvt_pk_bf16_f32 v199, v202, v203
    v_or3_b32 v230, v230, v192, v193
    v_mfma_f32_16x16x32_bf16 v[20:23], a[176:179], a[104:107], 0
    v_or3_b32 v230, v230, v194, v195
    s_waitcnt vmcnt(9) lgkmcnt(0)
    v_mfma_f32_16x16x32_bf16 v[20:23], a[180:183], a[108:111], v[20:23]
    s_barrier
    v_mfma_f32_16x16x32_bf16 v[20:23], a[184:187], a[112:115], v[20:23]
    ds_read_b64_tr_b16 a[200:201], v211 offset:12288
    v_or3_b32 v230, v230, v196, v197
    v_mfma_f32_16x16x32_bf16 v[20:23], a[188:191], a[116:119], v[20:23]
    ds_read_b64_tr_b16 a[202:203], v211 offset:18432
    s_add_u32 m0, s22, 98304
    v_mfma_f32_16x16x32_bf16 v[20:23], a[192:195], a[120:123], v[20:23]
    ds_read_b64_tr_b16 a[204:205], v211 offset:12296
    buffer_load_dwordx4 v216, s[8:11], s25 offen nt lds
    v_mfma_f32_16x16x32_bf16 v[20:23], a[196:199], a[124:127], v[20:23]
    ds_read_b64_tr_b16 a[206:207], v211 offset:18440
    v_or3_b32 v230, v230, v198, v199
    v_mfma_f32_16x16x32_bf16 v[24:27], a[176:179], a[128:131], 0
    ds_read_b64_tr_b16 a[208:209], v212 offset:12288
    v_and_b32 v230, 0x40004000, v230
    v_mfma_f32_16x16x32_bf16 v[24:27], a[180:183], a[132:135], v[24:27]
    ds_read_b64_tr_b16 a[210:211], v212 offset:18432
    v_cmp_ne_u32 vcc, 0, v230
    v_mfma_f32_16x16x32_bf16 v[24:27], a[184:187], a[136:139], v[24:27]
    buffer_load_dwordx4 v217, s[8:11], s25 offen offset:1024 nt lds
    v_mfma_f32_16x16x32_bf16 v[24:27], a[188:191], a[140:143], v[24:27]
    v_mfma_f32_16x16x32_bf16 v[24:27], a[192:195], a[144:147], v[24:27]
    ds_read_b64_tr_b16 a[212:213], v212 offset:12296
    v_mfma_f32_16x16x32_bf16 v[24:27], a[196:199], a[148:151], v[24:27]
    ds_read_b64_tr_b16 a[214:215], v212 offset:18440
    v_mfma_f32_16x16x32_bf16 v[28:31], a[176:179], a[152:155], 0
    buffer_load_dwordx4 v218, s[8:11], s25 offen offset:2048 nt lds
    v_mfma_f32_16x16x32_bf16 v[28:31], a[180:183], a[156:159], v[28:31]
    v_mfma_f32_16x16x32_bf16 v[28:31], a[184:187], a[160:163], v[28:31]
    ds_read_b64_tr_b16 a[216:217], v211 offset:12416
    v_mfma_f32_16x16x32_bf16 v[28:31], a[188:191], a[164:167], v[28:31]
    ds_read_b64_tr_b16 a[218:219], v211 offset:18560
    v_mfma_f32_16x16x32_bf16 v[28:31], a[192:195], a[168:171], v[28:31]
    s_add_u32 s25, s25, 12288
    v_mfma_f32_16x16x32_bf16 v[28:31], a[196:199], a[172:175], v[28:31]
    s_cbranch_vccnz L_rare_b7o
L_ret_b7o:
    s_waitcnt lgkmcnt(6)
    v_mfma_f32_16x16x32_bf16 v[64:67], a[200:203], v[180:183], v[64:67]
    ds_read_b64_tr_b16 a[220:221], v211 offset:12424
    v_max3_f32 v240, v0, v1, v2
    v_mfma_f32_16x16x32_bf16 v[68:71], a[200:203], v[188:191], v[68:71]
    ds_read_b64_tr_b16 a[222:223], v211 offset:18568
    v_max3_f32 v240, v240, v3, v16
    v_max3_f32 v240, v240, v17, v18
    v_mfma_f32_16x16x32_bf16 v[72:75], a[200:203], v[192:195], v[72:75]
    v_max_f32 v240, v240, v19
    v_max3_f32 v241, v4, v5, v6
    v_max3_f32 v241, v241, v7, v20
    v_mfma_f32_16x16x32_bf16 v[76:79], a[200:203], v[196:199], v[76:79]
    ds_read_b64_tr_b16 a[200:201], v212 offset:12416
    v_max3_f32 v241, v241, v21, v22
    v_mfma_f32_16x16x32_bf16 v[80:83], a[204:207], v[180:183], v[80:83]
    ds_read_b64_tr_b16 a[202:203], v212 offset:18560
    v_max_f32 v241, v241, v23
    v_max3_f32 v242, v8, v9, v10
    v_mfma_f32_16x16x32_bf16 v[84:87], a[204:207], v[188:191], v[84:87]
    v_max3_f32 v242, v242, v11, v24
    v_max3_f32 v242, v242, v25, v26
    v_max_f32 v242, v242, v27
    v_mfma_f32_16x16x32_bf16 v[88:91], a[204:207], v[192:195], v[88:91]
    v_max3_f32 v243, v12, v13, v14
    v_max3_f32 v243, v243, v15, v28
    v_mfma_f32_16x16x32_bf16 v[92:95], a[204:207], v[196:199], v[92:95]
    ds_read_b64_tr_b16 a[204:205], v212 offset:12424
    v_max3_f32 v243, v243, v29, v30
    s_waitcnt lgkmcnt(7)
    v_mfma_f32_16x16x32_bf16 v[96:99], a[208:211], v[180:183], v[96:99]
    ds_read_b64_tr_b16 a[206:207], v212 offset:18568
    v_max_f32 v243, v243, v31
    s_nop 1
    v_mfma_f32_16x16x32_bf16 v[100:103], a[208:211], v[188:191], v[100:103]
    v_permlane32_swap_b32 v240, v241
    v_mfma_f32_16x16x32_bf16 a[236:239], a[252:255], v[180:183], a[236:239]
    v_permlane32_swap_b32 v242, v243
    v_mfma_f32_16x16x32_bf16 v[104:107], a[208:211], v[192:195], v[104:107]
    v_max_f32 v240, v240, v241
    v_max_f32 v242, v242, v243
    s_nop 1
    v_mfma_f32_16x16x32_bf16 v[108:111], a[208:211], v[196:199], v[108:111]
    ds_read_b64_tr_b16 a[208:209], v211 offset:12544
    v_permlane16_swap_b32 v240, v242
    v_mfma_f32_16x16x32_bf16 v[112:115], a[212:215], v[180:183], v[112:115]
    ds_read_b64_tr_b16 a[210:211], v211 offset:18688
    v_max_f32 v240, v240, v242
    v_mfma_f32_16x16x32_bf16 v[116:119], a[212:215], v[188:191], v[116:119]
    v_mul_f32 v222, 0xbdd53b95, v240
    v_add_f32 v222, 0xc1000000, v222
    v_mfma_f32_16x16x32_bf16 v[120:123], a[212:215], v[192:195], v[120:123]
    v_mov_b32 v224, v222
    s_nop 1
    v_mfma_f32_16x16x32_bf16 v[124:127], a[212:215], v[196:199], v[124:127]
    ds_read_b64_tr_b16 a[212:213], v211 offset:12552
    v_permlane16_swap_b32 v222, v224
    s_waitcnt lgkmcnt(7)
    v_mfma_f32_16x16x32_bf16 v[128:131], a[216:219], v[180:183], v[128:131]
    ds_read_b64_tr_b16 a[214:215], v211 offset:18696
    v_mov_b32 v223, v222
    v_mfma_f32_16x16x32_bf16 v[132:135], a[216:219], v[188:191], v[132:135]
    v_mov_b32 v225, v224
    s_nop 0
    v_mfma_f32_16x16x32_bf16 v[136:139], a[216:219], v[192:195], v[136:139]
    v_permlane32_swap_b32 v222, v223
    v_permlane32_swap_b32 v224, v225
    v_mfma_f32_16x16x32_bf16 v[140:143], a[216:219], v[196:199], v[140:143]
    ds_read_b64_tr_b16 a[216:217], v212 offset:12544
    v_fma_f32 v0, v0, s20, v222
    v_mfma_f32_16x16x32_bf16 v[144:147], a[220:223], v[180:183], v[144:147]
    ds_read_b64_tr_b16 a[218:219], v212 offset:18688
    v_fma_f32 v1, v1, s20, v222
    v_mfma_f32_16x16x32_bf16 v[148:151], a[220:223], v[188:191], v[148:151]
    v_exp_f32 v200, v0
    v_fma_f32 v2, v2, s20, v222
    v_mfma_f32_16x16x32_bf16 a[240:243], a[252:255], v[188:191], a[240:243]
    v_exp_f32 v201, v1
    v_fma_f32 v3, v3, s20, v222
    v_mfma_f32_16x16x32_bf16 v[152:155], a[220:223], v[192:195], v[152:155]
    v_exp_f32 v202, v2
    v_mfma_f32_16x16x32_bf16 v[156:159], a[220:223], v[196:199], v[156:159]
    ds_read_b64_tr_b16 a[220:221], v212 offset:12552
    v_cvt_pk_bf16_f32 v176, v200, v201
    s_waitcnt lgkmcnt(7)
    v_mfma_f32_16x16x32_bf16 v[160:163], a[200:203], v[180:183], v[160:163]
    ds_read_b64_tr_b16 a[222:223], v212 offset:18696
    v_exp_f32 v203, v3
    v_mfma_f32_16x16x32_bf16 v[164:167], a[200:203], v[188:191], v[164:167]
    v_cvt_pk_bf16_f32 v177, v202, v203
    v_fma_f32 v16, v16, s20, v222
    v_mfma_f32_16x16x32_bf16 v[168:171], a[200:203], v[192:195], v[168:171]
    v_exp_f32 v204, v16
    v_fma_f32 v17, v17, s20, v222
    v_mfma_f32_16x16x32_bf16 v[172:175], a[200:203], v[196:199], v[172:175]
    v_exp_f32 v205, v17
    v_fma_f32 v18, v18, s20, v222
    v_mfma_f32_16x16x32_bf16 a[0:3], a[204:207], v[180:183], a[0:3]
    v_exp_f32 v200, v18
    v_cvt_pk_bf16_f32 v178, v204, v205
    v_mfma_f32_16x16x32_bf16 a[4:7], a[204:207], v[188:191], a[4:7]
    v_fma_f32 v19, v19, s20, v222
    v_fma_f32 v4, v4, s20, v223
    v_mfma_f32_16x16x32_bf16 a[8:11], a[204:207], v[192:195], a[8:11]
    v_exp_f32 v201, v19
    s_waitcnt vmcnt(8) lgkmcnt(0)
    v_mfma_f32_16x16x32_bf16 a[12:15], a[204:207], v[196:199], a[12:15]
    s_barrier
    v_cvt_pk_bf16_f32 v179, v200, v201
    v_mfma_f32_16x16x32_bf16 a[16:19], a[208:211], v[180:183], a[16:19]
    ds_read_b128 a[176:179], v208 offset:24576
    v_fma_f32 v5, v5, s20, v223
    v_mfma_f32_16x16x32_bf16 a[20:23], a[208:211], v[188:191], a[20:23]
    s_add_u32 m0, s22, 110592
    v_exp_f32 v202, v4
    v_mfma_f32_16x16x32_bf16 a[244:247], a[252:255], v[192:195], a[244:247]
    v_exp_f32 v203, v5
    v_fma_f32 v6, v6, s20, v223
    v_mfma_f32_16x16x32_bf16 a[24:27], a[208:211], v[192:195], a[24:27]
    buffer_load_dwordx4 v219, s[12:15], s26 offen nt lds
    v_cvt_pk_bf16_f32 v184, v202, v203
    v_mfma_f32_16x16x32_bf16 a[28:31], a[208:211], v[196:199], a[28:31]
    ds_read_b128 a[180:183], v209 offset:24576
    v_fma_f32 v7, v7, s20, v223
    v_mfma_f32_16x16x32_bf16 a[32:35], a[212:215], v[180:183], a[32:35]
    v_exp_f32 v204, v6
    v_fma_f32 v20, v20, s20, v223
    v_mfma_f32_16x16x32_bf16 a[36:39], a[212:215], v[188:191], a[36:39]
    ds_read_b128 a[184:187], v208 offset:24704
    v_exp_f32 v205, v7
    v_mfma_f32_16x16x32_bf16 a[40:43], a[212:215], v[192:195], a[40:43]
    buffer_load_dwordx4 v220, s[12:15], s26 offen offset:1024 nt lds
    v_mfma_f32_16x16x32_bf16 a[44:47], a[212:215], v[196:199], a[44:47]
    ds_read_b128 a[188:191], v209 offset:24704
    v_exp_f32 v200, v20
    v_mfma_f32_16x16x32_bf16 a[48:51], a[216:219], v[180:183], a[48:51]
    v_cvt_pk_bf16_f32 v185, v204, v205
    v_fma_f32 v21, v21, s20, v223
    v_fma_f32 v22, v22, s20, v223
    v_mfma_f32_16x16x32_bf16 a[52:55], a[216:219], v[188:191], a[52:55]
    ds_read_b128 a[192:195], v208 offset:24832
    v_exp_f32 v201, v21
    v_mfma_f32_16x16x32_bf16 a[56:59], a[216:219], v[192:195], a[56:59]
    buffer_load_dwordx4 v221, s[12:15], s26 offen offset:2048 nt lds
    v_mfma_f32_16x16x32_bf16 a[60:63], a[216:219], v[196:199], a[60:63]
    ds_read_b128 a[196:199], v209 offset:24832
    v_exp_f32 v202, v22
    v_mfma_f32_16x16x32_bf16 a[64:67], a[220:223], v[180:183], a[64:67]
    v_cvt_pk_bf16_f32 v186, v200, v201
    v_fma_f32 v23, v23, s20, v223
    v_or_b32 v230, v176, v177
    v_mfma_f32_16x16x32_bf16 a[68:71], a[220:223], v[188:191], a[68:71]
    v_exp_f32 v203, v23
    v_mfma_f32_16x16x32_bf16 a[248:251], a[252:255], v[196:199], a[248:251]
    v_cvt_pk_bf16_f32 v187, v202, v203
    v_or3_b32 v230, v230, v178, v179
    v_or3_b32 v230, v230, v184, v185
    v_mfma_f32_16x16x32_bf16 a[72:75], a[220:223], v[192:195], a[72:75]
    s_add_u32 s26, s26, 12288
    v_or3_b32 v230, v230, v186, v187
    v_fma_f32 v8, v8, s20, v224
    v_mfma_f32_16x16x32_bf16 a[76:79], a[220:223], v[196:199], a[76:79]
    v_fma_f32 v9, v9, s20, v224
    v_fma_f32 v10, v10, s20, v224
    v_fma_f32 v11, v11, s20, v224
    s_nop 3
    v_accvgpr_read_b32 v244, a236
    v_accvgpr_read_b32 v246, a240
    v_accvgpr_read_b32 v248, a244
    v_accvgpr_read_b32 v250, a248
    v_rcp_f32 v244, v244
    v_rcp_f32 v246, v246
    v_rcp_f32 v248, v248
    v_rcp_f32 v250, v250
    v_mov_b32 v200, v236
    v_xor_b32 v201, 32, v236
    v_xor_b32 v202, 64, v236
    v_xor_b32 v203, 96, v236
    v_xor_b32 v201, 64, v236
    v_pk_mul_f32 v[64:65], v[64:65], v[244:245] op_sel_hi:[1,0]
    v_pk_mul_f32 v[66:67], v[66:67], v[244:245] op_sel_hi:[1,0]
    v_pk_mul_f32 v[80:81], v[80:81], v[244:245] op_sel_hi:[1,0]
    v_pk_mul_f32 v[82:83], v[82:83], v[244:245] op_sel_hi:[1,0]
    v_cvt_pk_bf16_f32 v32, v64, v65
    v_cvt_pk_bf16_f32 v33, v66, v67
    v_cvt_pk_bf16_f32 v34, v80, v81
    v_cvt_pk_bf16_f32 v35, v82, v83
    ds_write_b128 v200, v[32:35]
    v_pk_mul_f32 v[96:97], v[96:97], v[244:245] op_sel_hi:[1,0]
    v_pk_mul_f32 v[98:99], v[98:99], v[244:245] op_sel_hi:[1,0]
    v_pk_mul_f32 v[112:113], v[112:113], v[244:245] op_sel_hi:[1,0]
    v_pk_mul_f32 v[114:115], v[114:115], v[244:245] op_sel_hi:[1,0]
    v_cvt_pk_bf16_f32 v36, v96, v97
    v_cvt_pk_bf16_f32 v37, v98, v99
    v_cvt_pk_bf16_f32 v38, v112, v113
    v_cvt_pk_bf16_f32 v39, v114, v115
    ds_write_b128 v201, v[36:39]
    v_accvgpr_read_b32 v60, a0
    v_accvgpr_read_b32 v61, a1
    v_accvgpr_read_b32 v62, a2
    v_accvgpr_read_b32 v63, a3
    v_pk_mul_f32 v[128:129], v[128:129], v[244:245] op_sel_hi:[1,0]
    v_pk_mul_f32 v[130:131], v[130:131], v[244:245] op_sel_hi:[1,0]
    v_pk_mul_f32 v[144:145], v[144:145], v[244:245] op_sel_hi:[1,0]
    v_pk_mul_f32 v[146:147], v[146:147], v[244:245] op_sel_hi:[1,0]
    v_cvt_pk_bf16_f32 v40, v128, v129
    v_cvt_pk_bf16_f32 v41, v130, v131
    v_cvt_pk_bf16_f32 v42, v144, v145
    v_cvt_pk_bf16_f32 v43, v146, v147
    ds_write_b128 v200, v[40:43] offset:128
    v_pk_mul_f32 v[160:161], v[160:161], v[244:245] op_sel_hi:[1,0]
    v_pk_mul_f32 v[162:163], v[162:163], v[244:245] op_sel_hi:[1,0]
    v_pk_mul_f32 v[60:61], v[60:61], v[244:245] op_sel_hi:[1,0]
    v_pk_mul_f32 v[62:63], v[62:63], v[244:245] op_sel_hi:[1,0]
    v_cvt_pk_bf16_f32 v44, v160, v161
    v_cvt_pk_bf16_f32 v45, v162, v163
    v_cvt_pk_bf16_f32 v46, v60, v61
    v_cvt_pk_bf16_f32 v47, v62, v63
    ds_write_b128 v201, v[44:47] offset:128
    v_accvgpr_read_b32 v48, a16
    v_accvgpr_read_b32 v49, a17
    v_accvgpr_read_b32 v50, a18
    v_accvgpr_read_b32 v51, a19
    v_accvgpr_read_b32 v52, a32
    v_accvgpr_read_b32 v53, a33
    v_accvgpr_read_b32 v54, a34
    v_accvgpr_read_b32 v55, a35
    v_accvgpr_read_b32 v56, a48
    v_accvgpr_read_b32 v57, a49
    v_accvgpr_read_b32 v58, a50
    v_accvgpr_read_b32 v59, a51
    v_accvgpr_read_b32 v60, a64
    v_accvgpr_read_b32 v61, a65
    v_accvgpr_read_b32 v62, a66
    v_accvgpr_read_b32 v63, a67
    v_pk_mul_f32 v[48:49], v[48:49], v[244:245] op_sel_hi:[1,0]
    v_pk_mul_f32 v[50:51], v[50:51], v[244:245] op_sel_hi:[1,0]
    v_pk_mul_f32 v[52:53], v[52:53], v[244:245] op_sel_hi:[1,0]
    v_pk_mul_f32 v[54:55], v[54:55], v[244:245] op_sel_hi:[1,0]
    v_cvt_pk_bf16_f32 v32, v48, v49
    v_cvt_pk_bf16_f32 v33, v50, v51
    v_cvt_pk_bf16_f32 v34, v52, v53
    v_cvt_pk_bf16_f32 v35, v54, v55
    ds_write_b128 v200, v[32:35] offset:256
    v_pk_mul_f32 v[56:57], v[56:57], v[244:245] op_sel_hi:[1,0]
    v_pk_mul_f32 v[58:59], v[58:59], v[244:245] op_sel_hi:[1,0]
    v_pk_mul_f32 v[60:61], v[60:61], v[244:245] op_sel_hi:[1,0]
    v_pk_mul_f32 v[62:63], v[62:63], v[244:245] op_sel_hi:[1,0]
    v_cvt_pk_bf16_f32 v36, v56, v57
    v_cvt_pk_bf16_f32 v37, v58, v59
    v_cvt_pk_bf16_f32 v38, v60, v61
    v_cvt_pk_bf16_f32 v39, v62, v63
    ds_write_b128 v201, v[36:39] offset:256
    v_pk_mul_f32 v[68:69], v[68:69], v[246:247] op_sel_hi:[1,0]
    v_pk_mul_f32 v[70:71], v[70:71], v[246:247] op_sel_hi:[1,0]
    v_pk_mul_f32 v[84:85], v[84:85], v[246:247] op_sel_hi:[1,0]
    v_pk_mul_f32 v[86:87], v[86:87], v[246:247] op_sel_hi:[1,0]
    v_cvt_pk_bf16_f32 v40, v68, v69
    v_cvt_pk_bf16_f32 v41, v70, v71
    v_cvt_pk_bf16_f32 v42, v84, v85
    v_cvt_pk_bf16_f32 v43, v86, v87
    ds_write_b128 v200, v[40:43] offset:6144
    v_pk_mul_f32 v[100:101], v[100:101], v[246:247] op_sel_hi:[1,0]
    v_pk_mul_f32 v[102:103], v[102:103], v[246:247] op_sel_hi:[1,0]
    v_pk_mul_f32 v[116:117], v[116:117], v[246:247] op_sel_hi:[1,0]
    v_pk_mul_f32 v[118:119], v[118:119], v[246:247] op_sel_hi:[1,0]
    v_cvt_pk_bf16_f32 v44, v100, v101
    v_cvt_pk_bf16_f32 v45, v102, v103
    v_cvt_pk_bf16_f32 v46, v116, v117
    v_cvt_pk_bf16_f32 v47, v118, v119
    ds_write_b128 v201, v[44:47] offset:6144
    v_accvgpr_read_b32 v60, a4
    v_accvgpr_read_b32 v61, a5
    v_accvgpr_read_b32 v62, a6
    v_accvgpr_read_b32 v63, a7
    v_pk_mul_f32 v[132:133], v[132:133], v[246:247] op_sel_hi:[1,0]
    v_pk_mul_f32 v[134:135], v[134:135], v[246:247] op_sel_hi:[1,0]
    v_pk_mul_f32 v[148:149], v[148:149], v[246:247] op_sel_hi:[1,0]
    v_pk_mul_f32 v[150:151], v[150:151], v[246:247] op_sel_hi:[1,0]
    v_cvt_pk_bf16_f32 v32, v132, v133
    v_cvt_pk_bf16_f32 v33, v134, v135
    v_cvt_pk_bf16_f32 v34, v148, v149
    v_cvt_pk_bf16_f32 v35, v150, v151
    ds_write_b128 v200, v[32:35] offset:6272
    v_pk_mul_f32 v[164:165], v[164:165], v[246:247] op_sel_hi:[1,0]
    v_pk_mul_f32 v[166:167], v[166:167], v[246:247] op_sel_hi:[1,0]
    v_pk_mul_f32 v[60:61], v[60:61], v[246:247] op_sel_hi:[1,0]
    v_pk_mul_f32 v[62:63], v[62:63], v[246:247] op_sel_hi:[1,0]
    v_cvt_pk_bf16_f32 v36, v164, v165
    v_cvt_pk_bf16_f32 v37, v166, v167
    v_cvt_pk_bf16_f32 v38, v60, v61
    v_cvt_pk_bf16_f32 v39, v62, v63
    ds_write_b128 v201, v[36:39] offset:6272
    v_accvgpr_read_b32 v48, a20
    v_accvgpr_read_b32 v49, a21
    v_accvgpr_read_b32 v50, a22
    v_accvgpr_read_b32 v51, a23
    v_accvgpr_read_b32 v52, a36
    v_accvgpr_read_b32 v53, a37
    v_accvgpr_read_b32 v54, a38
    v_accvgpr_read_b32 v55, a39
    v_accvgpr_read_b32 v56, a52
    v_accvgpr_read_b32 v57, a53
    v_accvgpr_read_b32 v58, a54
    v_accvgpr_read_b32 v59, a55
    v_accvgpr_read_b32 v60, a68
    v_accvgpr_read_b32 v61, a69
    v_accvgpr_read_b32 v62, a70
    v_accvgpr_read_b32 v63, a71
    v_pk_mul_f32 v[48:49], v[48:49], v[246:247] op_sel_hi:[1,0]
    v_pk_mul_f32 v[50:51], v[50:51], v[246:247] op_sel_hi:[1,0]
    v_pk_mul_f32 v[52:53], v[52:53], v[246:247] op_sel_hi:[1,0]
    v_pk_mul_f32 v[54:55], v[54:55], v[246:247] op_sel_hi:[1,0]
    v_cvt_pk_bf16_f32 v40, v48, v49
    v_cvt_pk_bf16_f32 v41, v50, v51
    v_cvt_pk_bf16_f32 v42, v52, v53
    v_cvt_pk_bf16_f32 v43, v54, v55
    ds_write_b128 v200, v[40:43] offset:6400
    v_pk_mul_f32 v[56:57], v[56:57], v[246:247] op_sel_hi:[1,0]
    v_pk_mul_f32 v[58:59], v[58:59], v[246:247] op_sel_hi:[1,0]
    v_pk_mul_f32 v[60:61], v[60:61], v[246:247] op_sel_hi:[1,0]
    v_pk_mul_f32 v[62:63], v[62:63], v[246:247] op_sel_hi:[1,0]
    v_cvt_pk_bf16_f32 v44, v56, v57
    v_cvt_pk_bf16_f32 v45, v58, v59
    v_cvt_pk_bf16_f32 v46, v60, v61
    v_cvt_pk_bf16_f32 v47, v62, v63
    ds_write_b128 v201, v[44:47] offset:6400
    v_pk_mul_f32 v[72:73], v[72:73], v[248:249] op_sel_hi:[1,0]
    v_pk_mul_f32 v[74:75], v[74:75], v[248:249] op_sel_hi:[1,0]
    v_pk_mul_f32 v[88:89], v[88:89], v[248:249] op_sel_hi:[1,0]
    v_pk_mul_f32 v[90:91], v[90:91], v[248:249] op_sel_hi:[1,0]
    v_cvt_pk_bf16_f32 v32, v72, v73
    v_cvt_pk_bf16_f32 v33, v74, v75
    v_cvt_pk_bf16_f32 v34, v88, v89
    v_cvt_pk_bf16_f32 v35, v90, v91
    ds_write_b128 v200, v[32:35] offset:12288
    v_pk_mul_f32 v[104:105], v[104:105], v[248:249] op_sel_hi:[1,0]
    v_pk_mul_f32 v[106:107], v[106:107], v[248:249] op_sel_hi:[1,0]
    v_pk_mul_f32 v[120:121], v[120:121], v[248:249] op_sel_hi:[1,0]
    v_pk_mul_f32 v[122:123], v[122:123], v[248:249] op_sel_hi:[1,0]
    v_cvt_pk_bf16_f32 v36, v104, v105
    v_cvt_pk_bf16_f32 v37, v106, v107
    v_cvt_pk_bf16_f32 v38, v120, v121
    v_cvt_pk_bf16_f32 v39, v122, v123
    ds_write_b128 v201, v[36:39] offset:12288
    v_accvgpr_read_b32 v60, a8
    v_accvgpr_read_b32 v61, a9
    v_accvgpr_read_b32 v62, a10
    v_accvgpr_read_b32 v63, a11
    v_pk_mul_f32 v[136:137], v[136:137], v[248:249] op_sel_hi:[1,0]
    v_pk_mul_f32 v[138:139], v[138:139], v[248:249] op_sel_hi:[1,0]
    v_pk_mul_f32 v[152:153], v[152:153], v[248:249] op_sel_hi:[1,0]
    v_pk_mul_f32 v[154:155], v[154:155], v[248:249] op_sel_hi:[1,0]
    v_cvt_pk_bf16_f32 v40, v136, v137
    v_cvt_pk_bf16_f32 v41, v138, v139
    v_cvt_pk_bf16_f32 v42, v152, v153
    v_cvt_pk_bf16_f32 v43, v154, v155
    ds_write_b128 v200, v[40:43] offset:12416
    v_pk_mul_f32 v[168:169], v[168:169], v[248:249] op_sel_hi:[1,0]
    v_pk_mul_f32 v[170:171], v[170:171], v[248:249] op_sel_hi:[1,0]
    v_pk_mul_f32 v[60:61], v[60:61], v[248:249] op_sel_hi:[1,0]
    v_pk_mul_f32 v[62:63], v[62:63], v[248:249] op_sel_hi:[1,0]
    v_cvt_pk_bf16_f32 v44, v168, v169
    v_cvt_pk_bf16_f32 v45, v170, v171
    v_cvt_pk_bf16_f32 v46, v60, v61
    v_cvt_pk_bf16_f32 v47, v62, v63
    ds_write_b128 v201, v[44:47] offset:12416
    v_accvgpr_read_b32 v48, a24
    v_accvgpr_read_b32 v49, a25
    v_accvgpr_read_b32 v50, a26
    v_accvgpr_read_b32 v51, a27
    v_accvgpr_read_b32 v52, a40
    v_accvgpr_read_b32 v53, a41
    v_accvgpr_read_b32 v54, a42
    v_accvgpr_read_b32 v55, a43
    v_accvgpr_read_b32 v56, a56
    v_accvgpr_read_b32 v57, a57
    v_accvgpr_read_b32 v58, a58
    v_accvgpr_read_b32 v59, a59
    v_accvgpr_read_b32 v60, a72
    v_accvgpr_read_b32 v61, a73
    v_accvgpr_read_b32 v62, a74
    v_accvgpr_read_b32 v63, a75
    v_pk_mul_f32 v[48:49], v[48:49], v[248:249] op_sel_hi:[1,0]
    v_pk_mul_f32 v[50:51], v[50:51], v[248:249] op_sel_hi:[1,0]
    v_pk_mul_f32 v[52:53], v[52:53], v[248:249] op_sel_hi:[1,0]
    v_pk_mul_f32 v[54:55], v[54:55], v[248:249] op_sel_hi:[1,0]
    v_cvt_pk_bf16_f32 v32, v48, v49
    v_cvt_pk_bf16_f32 v33, v50, v51
    v_cvt_pk_bf16_f32 v34, v52, v53
    v_cvt_pk_bf16_f32 v35, v54, v55
    ds_write_b128 v200, v[32:35] offset:12544
    v_pk_mul_f32 v[56:57], v[56:57], v[248:249] op_sel_hi:[1,0]
    v_pk_mul_f32 v[58:59], v[58:59], v[248:249] op_sel_hi:[1,0]
    v_pk_mul_f32 v[60:61], v[60:61], v[248:249] op_sel_hi:[1,0]
    v_pk_mul_f32 v[62:63], v[62:63], v[248:249] op_sel_hi:[1,0]
    v_cvt_pk_bf16_f32 v36, v56, v57
    v_cvt_pk_bf16_f32 v37, v58, v59
    v_cvt_pk_bf16_f32 v38, v60, v61
    v_cvt_pk_bf16_f32 v39, v62, v63
    ds_write_b128 v201, v[36:39] offset:12544
    v_pk_mul_f32 v[76:77], v[76:77], v[250:251] op_sel_hi:[1,0]
    v_pk_mul_f32 v[78:79], v[78:79], v[250:251] op_sel_hi:[1,0]
    v_pk_mul_f32 v[92:93], v[92:93], v[250:251] op_sel_hi:[1,0]
    v_pk_mul_f32 v[94:95], v[94:95], v[250:251] op_sel_hi:[1,0]
    v_cvt_pk_bf16_f32 v40, v76, v77
    v_cvt_pk_bf16_f32 v41, v78, v79
    v_cvt_pk_bf16_f32 v42, v92, v93
    v_cvt_pk_bf16_f32 v43, v94, v95
    ds_write_b128 v200, v[40:43] offset:18432
    v_pk_mul_f32 v[108:109], v[108:109], v[250:251] op_sel_hi:[1,0]
    v_pk_mul_f32 v[110:111], v[110:111], v[250:251] op_sel_hi:[1,0]
    v_pk_mul_f32 v[124:125], v[124:125], v[250:251] op_sel_hi:[1,0]
    v_pk_mul_f32 v[126:127], v[126:127], v[250:251] op_sel_hi:[1,0]
    v_cvt_pk_bf16_f32 v44, v108, v109
    v_cvt_pk_bf16_f32 v45, v110, v111
    v_cvt_pk_bf16_f32 v46, v124, v125
    v_cvt_pk_bf16_f32 v47, v126, v127
    ds_write_b128 v201, v[44:47] offset:18432
    v_accvgpr_read_b32 v60, a12
    v_accvgpr_read_b32 v61, a13
    v_accvgpr_read_b32 v62, a14
    v_accvgpr_read_b32 v63, a15
    v_pk_mul_f32 v[140:141], v[140:141], v[250:251] op_sel_hi:[1,0]
    v_pk_mul_f32 v[142:143], v[142:143], v[250:251] op_sel_hi:[1,0]
    v_pk_mul_f32 v[156:157], v[156:157], v[250:251] op_sel_hi:[1,0]
    v_pk_mul_f32 v[158:159], v[158:159], v[250:251] op_sel_hi:[1,0]
    v_cvt_pk_bf16_f32 v32, v140, v141
    v_cvt_pk_bf16_f32 v33, v142, v143
    v_cvt_pk_bf16_f32 v34, v156, v157
    v_cvt_pk_bf16_f32 v35, v158, v159
    ds_write_b128 v200, v[32:35] offset:18560
    v_pk_mul_f32 v[172:173], v[172:173], v[250:251] op_sel_hi:[1,0]
    v_pk_mul_f32 v[174:175], v[174:175], v[250:251] op_sel_hi:[1,0]
    v_pk_mul_f32 v[60:61], v[60:61], v[250:251] op_sel_hi:[1,0]
    v_pk_mul_f32 v[62:63], v[62:63], v[250:251] op_sel_hi:[1,0]
    v_cvt_pk_bf16_f32 v36, v172, v173
    v_cvt_pk_bf16_f32 v37, v174, v175
    v_cvt_pk_bf16_f32 v38, v60, v61
    v_cvt_pk_bf16_f32 v39, v62, v63
    ds_write_b128 v201, v[36:39] offset:18560
    v_accvgpr_read_b32 v48, a28
    v_accvgpr_read_b32 v49, a29
    v_accvgpr_read_b32 v50, a30
    v_accvgpr_read_b32 v51, a31
    v_accvgpr_read_b32 v52, a44
    v_accvgpr_read_b32 v53, a45
    v_accvgpr_read_b32 v54, a46
    v_accvgpr_read_b32 v55, a47
    v_accvgpr_read_b32 v56, a60
    v_accvgpr_read_b32 v57, a61
    v_accvgpr_read_b32 v58, a62
    v_accvgpr_read_b32 v59, a63
    v_accvgpr_read_b32 v60, a76
    v_accvgpr_read_b32 v61, a77
    v_accvgpr_read_b32 v62, a78
    v_accvgpr_read_b32 v63, a79
    v_pk_mul_f32 v[48:49], v[48:49], v[250:251] op_sel_hi:[1,0]
    v_pk_mul_f32 v[50:51], v[50:51], v[250:251] op_sel_hi:[1,0]
    v_pk_mul_f32 v[52:53], v[52:53], v[250:251] op_sel_hi:[1,0]
    v_pk_mul_f32 v[54:55], v[54:55], v[250:251] op_sel_hi:[1,0]
    v_cvt_pk_bf16_f32 v40, v48, v49
    v_cvt_pk_bf16_f32 v41, v50, v51
    v_cvt_pk_bf16_f32 v42, v52, v53
    v_cvt_pk_bf16_f32 v43, v54, v55
    ds_write_b128 v200, v[40:43] offset:18688
    v_pk_mul_f32 v[56:57], v[56:57], v[250:251] op_sel_hi:[1,0]
    v_pk_mul_f32 v[58:59], v[58:59], v[250:251] op_sel_hi:[1,0]
    v_pk_mul_f32 v[60:61], v[60:61], v[250:251] op_sel_hi:[1,0]
    v_pk_mul_f32 v[62:63], v[62:63], v[250:251] op_sel_hi:[1,0]
    v_cvt_pk_bf16_f32 v44, v56, v57
    v_cvt_pk_bf16_f32 v45, v58, v59
    v_cvt_pk_bf16_f32 v46, v60, v61
    v_cvt_pk_bf16_f32 v47, v62, v63
    ds_write_b128 v201, v[44:47] offset:18688
    v_subrev_u32 v237, 24576, v237
    v_subrev_u32 v238, 24576, v238
    v_subrev_u32 v239, 24576, v239
    s_mov_b32 s38, s29
    s_add_u32 s29, s29, 25165824
    s_add_u32 s32, s32, 25165824
    s_add_u32 s27, s29, 25165824
    s_mov_b32 s28, s33
    s_mov_b32 s78, 100663296
    s_mov_b32 s79, 100663296
    s_add_u32 s31, s31, 1
    s_branch L_block
L_last:
    s_mov_b32 s30, 8
    s_waitcnt lgkmcnt(0)
    v_mfma_f32_16x16x32_bf16 v[32:35], a[176:179], a[80:83], 0
    v_exp_f32 v200, v8
    v_mfma_f32_16x16x32_bf16 v[32:35], a[180:183], a[84:87], v[32:35]
    ds_read_b128 a[200:203], v208 offset:30720
    v_fma_f32 v24, v24, s20, v224
    v_mfma_f32_16x16x32_bf16 v[32:35], a[184:187], a[88:91], v[32:35]
    v_exp_f32 v201, v9
    v_mfma_f32_16x16x32_bf16 v[32:35], a[188:191], a[92:95], v[32:35]
    ds_read_b128 a[204:207], v209 offset:30720
    v_cvt_pk_bf16_f32 v192, v200, v201
    v_mfma_f32_16x16x32_bf16 v[32:35], a[192:195], a[96:99], v[32:35]
    v_exp_f32 v202, v10
    v_mfma_f32_16x16x32_bf16 v[32:35], a[196:199], a[100:103], v[32:35]
    ds_read_b128 a[208:211], v208 offset:30848
    v_fma_f32 v25, v25, s20, v224
    v_mfma_f32_16x16x32_bf16 v[36:39], a[176:179], a[104:107], 0
    v_exp_f32 v203, v11
    v_mfma_f32_16x16x32_bf16 v[36:39], a[180:183], a[108:111], v[36:39]
    ds_read_b128 a[212:215], v209 offset:30848
    v_cvt_pk_bf16_f32 v193, v202, v203
    v_mfma_f32_16x16x32_bf16 v[36:39], a[184:187], a[112:115], v[36:39]
    v_exp_f32 v204, v24
    v_mfma_f32_16x16x32_bf16 v[36:39], a[188:191], a[116:119], v[36:39]
    ds_read_b128 a[216:219], v208 offset:30976
    v_fma_f32 v26, v26, s20, v224
    v_mfma_f32_16x16x32_bf16 v[36:39], a[192:195], a[120:123], v[36:39]
    v_exp_f32 v205, v25
    v_mfma_f32_16x16x32_bf16 v[36:39], a[196:199], a[124:127], v[36:39]
    ds_read_b128 a[220:223], v209 offset:30976
    v_cvt_pk_bf16_f32 v194, v204, v205
    v_mfma_f32_16x16x32_bf16 v[40:43], a[176:179], a[128:131], 0
    buffer_store_dwordx4 a[224:227], v235, s[16:19], s38 offen nt
    v_mfma_f32_16x16x32_bf16 v[40:43], a[180:183], a[132:135], v[40:43]
    v_exp_f32 v200, v26
    v_mfma_f32_16x16x32_bf16 v[40:43], a[184:187], a[136:139], v[40:43]
    v_fma_f32 v27, v27, s20, v224
    v_fma_f32 v12, v12, s20, v225
    v_mfma_f32_16x16x32_bf16 v[40:43], a[188:191], a[140:143], v[40:43]
    v_exp_f32 v201, v27
    v_mfma_f32_16x16x32_bf16 v[40:43], a[192:195], a[144:147], v[40:43]
    v_exp_f32 v202, v12
    v_mfma_f32_16x16x32_bf16 v[40:43], a[196:199], a[148:151], v[40:43]
    v_cvt_pk_bf16_f32 v195, v200, v201
    v_fma_f32 v13, v13, s20, v225
    v_mfma_f32_16x16x32_bf16 v[44:47], a[176:179], a[152:155], 0
    v_exp_f32 v203, v13
    v_mfma_f32_16x16x32_bf16 v[44:47], a[180:183], a[156:159], v[44:47]
    v_cvt_pk_bf16_f32 v196, v202, v203
    v_fma_f32 v14, v14, s20, v225
    v_mfma_f32_16x16x32_bf16 v[44:47], a[184:187], a[160:163], v[44:47]
    v_exp_f32 v204, v14
    v_mfma_f32_16x16x32_bf16 v[44:47], a[188:191], a[164:167], v[44:47]
    v_fma_f32 v15, v15, s20, v225
    v_fma_f32 v28, v28, s20, v225
    v_mfma_f32_16x16x32_bf16 v[44:47], a[192:195], a[168:171], v[44:47]
    v_exp_f32 v205, v15
    v_mfma_f32_16x16x32_bf16 v[44:47], a[196:199], a[172:175], v[44:47]
    v_cvt_pk_bf16_f32 v197, v204, v205
    s_waitcnt lgkmcnt(0)
    v_mfma_f32_16x16x32_bf16 v[48:51], a[200:203], a[80:83], 0
    v_exp_f32 v200, v28
    v_mfma_f32_16x16x32_bf16 v[48:51], a[204:207], a[84:87], v[48:51]
    v_fma_f32 v29, v29, s20, v225
    v_fma_f32 v30, v30, s20, v225
    v_mfma_f32_16x16x32_bf16 v[48:51], a[208:211], a[88:91], v[48:51]
    v_exp_f32 v201, v29
    v_mfma_f32_16x16x32_bf16 v[48:51], a[212:215], a[92:95], v[48:51]
    v_exp_f32 v202, v30
    v_mfma_f32_16x16x32_bf16 v[48:51], a[216:219], a[96:99], v[48:51]
    v_cvt_pk_bf16_f32 v198, v200, v201
    v_fma_f32 v31, v31, s20, v225
    v_mfma_f32_16x16x32_bf16 v[48:51], a[220:223], a[100:103], v[48:51]
    v_exp_f32 v203, v31
    v_mfma_f32_16x16x32_bf16 v[52:55], a[200:203], a[104:107], 0
    v_cvt_pk_bf16_f32 v199, v202, v203
    s_waitcnt vmcnt(10) lgkmcnt(0)
    v_mfma_f32_16x16x32_bf16 v[52:55], a[204:207], a[108:111], v[52:55]
    s_barrier
    v_mfma_f32_16x16x32_bf16 v[52:55], a[208:211], a[112:115], v[52:55]
    ds_read_b64_tr_b16 a[176:177], v211 offset:36864
    v_or3_b32 v230, v230, v192, v193
    v_mfma_f32_16x16x32_bf16 v[52:55], a[212:215], a[116:119], v[52:55]
    ds_read_b64_tr_b16 a[178:179], v211 offset:43008
    v_or3_b32 v230, v230, v194, v195
    v_mfma_f32_16x16x32_bf16 v[52:55], a[216:219], a[120:123], v[52:55]
    ds_read_b64_tr_b16 a[180:181], v211 offset:36872
    v_or3_b32 v230, v230, v196, v197
    v_mfma_f32_16x16x32_bf16 v[52:55], a[220:223], a[124:127], v[52:55]
    ds_read_b64_tr_b16 a[182:183], v211 offset:43016
    v_or3_b32 v230, v230, v198, v199
    v_mfma_f32_16x16x32_bf16 v[56:59], a[200:203], a[128:131], 0
    ds_read_b64_tr_b16 a[184:185], v212 offset:36864
    v_and_b32 v230, 0x40004000, v230
    v_mfma_f32_16x16x32_bf16 v[56:59], a[204:207], a[132:135], v[56:59]
    ds_read_b64_tr_b16 a[186:187], v212 offset:43008
    v_cmp_ne_u32 vcc, 0, v230
    v_mfma_f32_16x16x32_bf16 v[56:59], a[208:211], a[136:139], v[56:59]
    v_mfma_f32_16x16x32_bf16 v[56:59], a[212:215], a[140:143], v[56:59]
    v_mfma_f32_16x16x32_bf16 v[56:59], a[216:219], a[144:147], v[56:59]
    ds_read_b64_tr_b16 a[188:189], v212 offset:36872
    v_mfma_f32_16x16x32_bf16 v[56:59], a[220:223], a[148:151], v[56:59]
    ds_read_b64_tr_b16 a[190:191], v212 offset:43016
    v_mfma_f32_16x16x32_bf16 v[60:63], a[200:203], a[152:155], 0
    v_mfma_f32_16x16x32_bf16 v[60:63], a[204:207], a[156:159], v[60:63]
    v_mfma_f32_16x16x32_bf16 v[60:63], a[208:211], a[160:163], v[60:63]
    ds_read_b64_tr_b16 a[192:193], v211 offset:36992
    v_mfma_f32_16x16x32_bf16 v[60:63], a[212:215], a[164:167], v[60:63]
    ds_read_b64_tr_b16 a[194:195], v211 offset:43136
    v_mfma_f32_16x16x32_bf16 v[60:63], a[216:219], a[168:171], v[60:63]
    v_mfma_f32_16x16x32_bf16 v[60:63], a[220:223], a[172:175], v[60:63]
    s_cbranch_vccnz L_rare_ble
L_ret_ble:
    s_waitcnt lgkmcnt(6)
    v_mfma_f32_16x16x32_bf16 v[64:67], a[176:179], v[176:179], v[64:67]
    ds_read_b64_tr_b16 a[196:197], v211 offset:37000
    v_fma_f32 v32, v32, s20, v222
    v_mfma_f32_16x16x32_bf16 v[68:71], a[176:179], v[184:187], v[68:71]
    ds_read_b64_tr_b16 a[198:199], v211 offset:43144
    v_fma_f32 v33, v33, s20, v222
    v_mfma_f32_16x16x32_bf16 v[72:75], a[176:179], v[192:195], v[72:75]
    v_exp_f32 v200, v32
    v_mfma_f32_16x16x32_bf16 v[76:79], a[176:179], v[196:199], v[76:79]
    ds_read_b64_tr_b16 a[176:177], v212 offset:36992
    v_fma_f32 v34, v34, s20, v222
    v_mfma_f32_16x16x32_bf16 v[80:83], a[180:183], v[176:179], v[80:83]
    ds_read_b64_tr_b16 a[178:179], v212 offset:43136
    v_fma_f32 v35, v35, s20, v222
    v_mfma_f32_16x16x32_bf16 v[84:87], a[180:183], v[184:187], v[84:87]
    v_exp_f32 v201, v33
    v_mfma_f32_16x16x32_bf16 v[88:91], a[180:183], v[192:195], v[88:91]
    v_exp_f32 v202, v34
    v_mfma_f32_16x16x32_bf16 v[92:95], a[180:183], v[196:199], v[92:95]
    ds_read_b64_tr_b16 a[180:181], v212 offset:37000
    s_waitcnt lgkmcnt(7)
    v_mfma_f32_16x16x32_bf16 v[96:99], a[184:187], v[176:179], v[96:99]
    ds_read_b64_tr_b16 a[182:183], v212 offset:43144
    v_cvt_pk_bf16_f32 v180, v200, v201
    v_mfma_f32_16x16x32_bf16 v[100:103], a[184:187], v[184:187], v[100:103]
    v_exp_f32 v203, v35
    v_mfma_f32_16x16x32_bf16 a[236:239], a[252:255], v[176:179], a[236:239]
    v_cvt_pk_bf16_f32 v181, v202, v203
    v_fma_f32 v48, v48, s20, v222
    v_mfma_f32_16x16x32_bf16 v[104:107], a[184:187], v[192:195], v[104:107]
    v_exp_f32 v204, v48
    v_mfma_f32_16x16x32_bf16 v[108:111], a[184:187], v[196:199], v[108:111]
    ds_read_b64_tr_b16 a[184:185], v211 offset:37120
    v_fma_f32 v49, v49, s20, v222
    v_mfma_f32_16x16x32_bf16 v[112:115], a[188:191], v[176:179], v[112:115]
    ds_read_b64_tr_b16 a[186:187], v211 offset:43264
    buffer_store_dwordx4 a[228:231], v235, s[16:19], s38 offen offset:1024 nt
    v_mfma_f32_16x16x32_bf16 v[116:119], a[188:191], v[184:187], v[116:119]
    v_exp_f32 v205, v49
    v_mfma_f32_16x16x32_bf16 v[120:123], a[188:191], v[192:195], v[120:123]
    v_cvt_pk_bf16_f32 v182, v204, v205
    v_fma_f32 v50, v50, s20, v222
    v_mfma_f32_16x16x32_bf16 v[124:127], a[188:191], v[196:199], v[124:127]
    ds_read_b64_tr_b16 a[188:189], v211 offset:37128
    s_waitcnt lgkmcnt(7)
    v_mfma_f32_16x16x32_bf16 v[128:131], a[192:195], v[176:179], v[128:131]
    ds_read_b64_tr_b16 a[190:191], v211 offset:43272
    v_fma_f32 v51, v51, s20, v222
    v_mfma_f32_16x16x32_bf16 v[132:135], a[192:195], v[184:187], v[132:135]
    v_exp_f32 v200, v50
    v_mfma_f32_16x16x32_bf16 v[136:139], a[192:195], v[192:195], v[136:139]
    v_exp_f32 v201, v51
    v_mfma_f32_16x16x32_bf16 v[140:143], a[192:195], v[196:199], v[140:143]
    ds_read_b64_tr_b16 a[192:193], v212 offset:37120
    v_cvt_pk_bf16_f32 v183, v200, v201
    v_mfma_f32_16x16x32_bf16 v[144:147], a[196:199], v[176:179], v[144:147]
    ds_read_b64_tr_b16 a[194:195], v212 offset:43264
    v_fma_f32 v36, v36, s20, v223
    v_mfma_f32_16x16x32_bf16 v[148:151], a[196:199], v[184:187], v[148:151]
    v_exp_f32 v202, v36
    v_mfma_f32_16x16x32_bf16 a[240:243], a[252:255], v[184:187], a[240:243]
    v_fma_f32 v37, v37, s20, v223
    v_fma_f32 v38, v38, s20, v223
    v_mfma_f32_16x16x32_bf16 v[152:155], a[196:199], v[192:195], v[152:155]
    v_exp_f32 v203, v37
    v_mfma_f32_16x16x32_bf16 v[156:159], a[196:199], v[196:199], v[156:159]
    ds_read_b64_tr_b16 a[196:197], v212 offset:37128
    s_waitcnt lgkmcnt(7)
    v_mfma_f32_16x16x32_bf16 v[160:163], a[176:179], v[176:179], v[160:163]
    ds_read_b64_tr_b16 a[198:199], v212 offset:43272
    v_cvt_pk_bf16_f32 v188, v202, v203
    v_mfma_f32_16x16x32_bf16 v[164:167], a[176:179], v[184:187], v[164:167]
    v_exp_f32 v204, v38
    v_mfma_f32_16x16x32_bf16 v[168:171], a[176:179], v[192:195], v[168:171]
    v_fma_f32 v39, v39, s20, v223
    v_fma_f32 v52, v52, s20, v223
    v_mfma_f32_16x16x32_bf16 v[172:175], a[176:179], v[196:199], v[172:175]
    v_exp_f32 v205, v39
    v_mfma_f32_16x16x32_bf16 a[0:3], a[180:183], v[176:179], a[0:3]
    buffer_store_dwordx4 a[232:235], v235, s[16:19], s38 offen offset:2048 nt
    s_add_u32 s38, s38, 3072
    v_mfma_f32_16x16x32_bf16 a[4:7], a[180:183], v[184:187], a[4:7]
    v_exp_f32 v200, v52
    v_mfma_f32_16x16x32_bf16 a[8:11], a[180:183], v[192:195], a[8:11]
    v_cvt_pk_bf16_f32 v189, v204, v205
    v_fma_f32 v53, v53, s20, v223
    v_mfma_f32_16x16x32_bf16 a[12:15], a[180:183], v[196:199], a[12:15]
    v_fma_f32 v54, v54, s20, v223
    s_waitcnt lgkmcnt(0)
    v_mfma_f32_16x16x32_bf16 a[16:19], a[184:187], v[176:179], a[16:19]
    v_exp_f32 v201, v53
    v_mfma_f32_16x16x32_bf16 a[20:23], a[184:187], v[184:187], a[20:23]
    v_exp_f32 v202, v54
    v_mfma_f32_16x16x32_bf16 a[244:247], a[252:255], v[192:195], a[244:247]
    v_cvt_pk_bf16_f32 v190, v200, v201
    v_fma_f32 v55, v55, s20, v223
    v_mfma_f32_16x16x32_bf16 a[24:27], a[184:187], v[192:195], a[24:27]
    v_exp_f32 v203, v55
    v_mfma_f32_16x16x32_bf16 a[28:31], a[184:187], v[196:199], a[28:31]
    v_cvt_pk_bf16_f32 v191, v202, v203
    v_or_b32 v230, v180, v181
    v_mfma_f32_16x16x32_bf16 a[32:35], a[188:191], v[176:179], a[32:35]
    v_or3_b32 v230, v230, v182, v183
    v_or3_b32 v230, v230, v188, v189
    v_mfma_f32_16x16x32_bf16 a[36:39], a[188:191], v[184:187], a[36:39]
    v_or3_b32 v230, v230, v190, v191
    v_fma_f32 v40, v40, s20, v224
    v_mfma_f32_16x16x32_bf16 a[40:43], a[188:191], v[192:195], a[40:43]
    v_fma_f32 v41, v41, s20, v224
    v_fma_f32 v42, v42, s20, v224
    v_mfma_f32_16x16x32_bf16 a[44:47], a[188:191], v[196:199], a[44:47]
    v_fma_f32 v43, v43, s20, v224
    v_mfma_f32_16x16x32_bf16 a[48:51], a[192:195], v[176:179], a[48:51]
    v_mfma_f32_16x16x32_bf16 a[52:55], a[192:195], v[184:187], a[52:55]
    v_mfma_f32_16x16x32_bf16 a[56:59], a[192:195], v[192:195], a[56:59]
    v_mfma_f32_16x16x32_bf16 a[60:63], a[192:195], v[196:199], a[60:63]
    v_mfma_f32_16x16x32_bf16 a[64:67], a[196:199], v[176:179], a[64:67]
    v_mfma_f32_16x16x32_bf16 a[68:71], a[196:199], v[184:187], a[68:71]
    v_mfma_f32_16x16x32_bf16 a[248:251], a[252:255], v[196:199], a[248:251]
    v_mfma_f32_16x16x32_bf16 a[72:75], a[196:199], v[192:195], a[72:75]
    v_mfma_f32_16x16x32_bf16 a[76:79], a[196:199], v[196:199], a[76:79]
    s_waitcnt vmcnt(3) lgkmcnt(0)
    s_barrier
    ds_read_b64_tr_b16 a[200:201], v211 offset:12288
    ds_read_b64_tr_b16 a[202:203], v211 offset:18432
    ds_read_b64_tr_b16 a[204:205], v211 offset:12296
    ds_read_b64_tr_b16 a[206:207], v211 offset:18440
    ds_read_b64_tr_b16 a[208:209], v212 offset:12288
    ds_read_b64_tr_b16 a[210:211], v212 offset:18432
    ds_read_b64_tr_b16 a[212:213], v212 offset:12296
    ds_read_b64_tr_b16 a[214:215], v212 offset:18440
    ds_read_b64_tr_b16 a[216:217], v211 offset:12416
    ds_read_b64_tr_b16 a[218:219], v211 offset:18560
    v_exp_f32 v200, v40
    v_exp_f32 v201, v41
    v_fma_f32 v56, v56, s20, v224
    v_fma_f32 v57, v57, s20, v224
    v_exp_f32 v202, v42
    v_exp_f32 v203, v43
    v_cvt_pk_bf16_f32 v192, v200, v201
    v_fma_f32 v58, v58, s20, v224
    v_fma_f32 v59, v59, s20, v224
    v_exp_f32 v204, v56
    v_exp_f32 v205, v57
    v_cvt_pk_bf16_f32 v193, v202, v203
    v_or3_b32 v230, v230, v192, v193
    v_fma_f32 v44, v44, s20, v225
    v_fma_f32 v45, v45, s20, v225
    v_exp_f32 v200, v58
    v_exp_f32 v201, v59
    v_cvt_pk_bf16_f32 v194, v204, v205
    v_fma_f32 v46, v46, s20, v225
    v_fma_f32 v47, v47, s20, v225
    v_exp_f32 v202, v44
    v_exp_f32 v203, v45
    v_cvt_pk_bf16_f32 v195, v200, v201
    v_or3_b32 v230, v230, v194, v195
    v_fma_f32 v60, v60, s20, v225
    v_fma_f32 v61, v61, s20, v225
    v_exp_f32 v204, v46
    v_exp_f32 v205, v47
    v_cvt_pk_bf16_f32 v196, v202, v203
    v_fma_f32 v62, v62, s20, v225
    v_fma_f32 v63, v63, s20, v225
    v_exp_f32 v200, v60
    v_exp_f32 v201, v61
    v_cvt_pk_bf16_f32 v197, v204, v205
    v_or3_b32 v230, v230, v196, v197
    v_exp_f32 v202, v62
    v_exp_f32 v203, v63
    v_cvt_pk_bf16_f32 v198, v200, v201
    v_cvt_pk_bf16_f32 v199, v202, v203
    v_or3_b32 v230, v230, v198, v199
    v_and_b32 v230, 0x40004000, v230
    v_cmp_ne_u32 vcc, 0, v230
    s_cbranch_vccnz L_rare_blo
L_ret_blo:
    s_waitcnt lgkmcnt(6)
    v_mfma_f32_16x16x32_bf16 v[64:67], a[200:203], v[180:183], v[64:67]
    ds_read_b64_tr_b16 a[220:221], v211 offset:12424
    v_mfma_f32_16x16x32_bf16 v[68:71], a[200:203], v[188:191], v[68:71]
    ds_read_b64_tr_b16 a[222:223], v211 offset:18568
    v_mfma_f32_16x16x32_bf16 v[72:75], a[200:203], v[192:195], v[72:75]
    v_mfma_f32_16x16x32_bf16 v[76:79], a[200:203], v[196:199], v[76:79]
    ds_read_b64_tr_b16 a[200:201], v212 offset:12416
    v_mfma_f32_16x16x32_bf16 v[80:83], a[204:207], v[180:183], v[80:83]
    ds_read_b64_tr_b16 a[202:203], v212 offset:18560
    v_mfma_f32_16x16x32_bf16 v[84:87], a[204:207], v[188:191], v[84:87]
    v_mfma_f32_16x16x32_bf16 v[88:91], a[204:207], v[192:195], v[88:91]
    v_mfma_f32_16x16x32_bf16 v[92:95], a[204:207], v[196:199], v[92:95]
    ds_read_b64_tr_b16 a[204:205], v212 offset:12424
    s_waitcnt lgkmcnt(7)
    v_mfma_f32_16x16x32_bf16 v[96:99], a[208:211], v[180:183], v[96:99]
    ds_read_b64_tr_b16 a[206:207], v212 offset:18568
    v_mfma_f32_16x16x32_bf16 v[100:103], a[208:211], v[188:191], v[100:103]
    v_mfma_f32_16x16x32_bf16 a[236:239], a[252:255], v[180:183], a[236:239]
    v_mfma_f32_16x16x32_bf16 v[104:107], a[208:211], v[192:195], v[104:107]
    v_mfma_f32_16x16x32_bf16 v[108:111], a[208:211], v[196:199], v[108:111]
    ds_read_b64_tr_b16 a[208:209], v211 offset:12544
    v_mfma_f32_16x16x32_bf16 v[112:115], a[212:215], v[180:183], v[112:115]
    ds_read_b64_tr_b16 a[210:211], v211 offset:18688
    v_mfma_f32_16x16x32_bf16 v[116:119], a[212:215], v[188:191], v[116:119]
    v_mfma_f32_16x16x32_bf16 v[120:123], a[212:215], v[192:195], v[120:123]
    v_mfma_f32_16x16x32_bf16 v[124:127], a[212:215], v[196:199], v[124:127]
    ds_read_b64_tr_b16 a[212:213], v211 offset:12552
    s_waitcnt lgkmcnt(7)
    v_mfma_f32_16x16x32_bf16 v[128:131], a[216:219], v[180:183], v[128:131]
    ds_read_b64_tr_b16 a[214:215], v211 offset:18696
    v_mfma_f32_16x16x32_bf16 v[132:135], a[216:219], v[188:191], v[132:135]
    v_mfma_f32_16x16x32_bf16 v[136:139], a[216:219], v[192:195], v[136:139]
    v_mfma_f32_16x16x32_bf16 v[140:143], a[216:219], v[196:199], v[140:143]
    ds_read_b64_tr_b16 a[216:217], v212 offset:12544
    v_mfma_f32_16x16x32_bf16 v[144:147], a[220:223], v[180:183], v[144:147]
    ds_read_b64_tr_b16 a[218:219], v212 offset:18688
    v_mfma_f32_16x16x32_bf16 v[148:151], a[220:223], v[188:191], v[148:151]
    v_mfma_f32_16x16x32_bf16 a[240:243], a[252:255], v[188:191], a[240:243]
    v_mfma_f32_16x16x32_bf16 v[152:155], a[220:223], v[192:195], v[152:155]
    v_mfma_f32_16x16x32_bf16 v[156:159], a[220:223], v[196:199], v[156:159]
    ds_read_b64_tr_b16 a[220:221], v212 offset:12552
    s_waitcnt lgkmcnt(7)
    v_mfma_f32_16x16x32_bf16 v[160:163], a[200:203], v[180:183], v[160:163]
    ds_read_b64_tr_b16 a[222:223], v212 offset:18696
    v_mfma_f32_16x16x32_bf16 v[164:167], a[200:203], v[188:191], v[164:167]
    v_mfma_f32_16x16x32_bf16 v[168:171], a[200:203], v[192:195], v[168:171]
    v_mfma_f32_16x16x32_bf16 v[172:175], a[200:203], v[196:199], v[172:175]
    v_mfma_f32_16x16x32_bf16 a[0:3], a[204:207], v[180:183], a[0:3]
    v_mfma_f32_16x16x32_bf16 a[4:7], a[204:207], v[188:191], a[4:7]
    v_mfma_f32_16x16x32_bf16 a[8:11], a[204:207], v[192:195], a[8:11]
    v_mfma_f32_16x16x32_bf16 a[12:15], a[204:207], v[196:199], a[12:15]
    s_waitcnt lgkmcnt(0)
    v_mfma_f32_16x16x32_bf16 a[16:19], a[208:211], v[180:183], a[16:19]
    v_mfma_f32_16x16x32_bf16 a[20:23], a[208:211], v[188:191], a[20:23]
    v_mfma_f32_16x16x32_bf16 a[244:247], a[252:255], v[192:195], a[244:247]
    v_mfma_f32_16x16x32_bf16 a[24:27], a[208:211], v[192:195], a[24:27]
    v_mfma_f32_16x16x32_bf16 a[28:31], a[208:211], v[196:199], a[28:31]
    v_mfma_f32_16x16x32_bf16 a[32:35], a[212:215], v[180:183], a[32:35]
    v_mfma_f32_16x16x32_bf16 a[36:39], a[212:215], v[188:191], a[36:39]
    v_mfma_f32_16x16x32_bf16 a[40:43], a[212:215], v[192:195], a[40:43]
    v_mfma_f32_16x16x32_bf16 a[44:47], a[212:215], v[196:199], a[44:47]
    v_mfma_f32_16x16x32_bf16 a[48:51], a[216:219], v[180:183], a[48:51]
    v_mfma_f32_16x16x32_bf16 a[52:55], a[216:219], v[188:191], a[52:55]
    v_mfma_f32_16x16x32_bf16 a[56:59], a[216:219], v[192:195], a[56:59]
    v_mfma_f32_16x16x32_bf16 a[60:63], a[216:219], v[196:199], a[60:63]
    v_mfma_f32_16x16x32_bf16 a[64:67], a[220:223], v[180:183], a[64:67]
    v_mfma_f32_16x16x32_bf16 a[68:71], a[220:223], v[188:191], a[68:71]
    v_mfma_f32_16x16x32_bf16 a[248:251], a[252:255], v[196:199], a[248:251]
    v_mfma_f32_16x16x32_bf16 a[72:75], a[220:223], v[192:195], a[72:75]
    v_mfma_f32_16x16x32_bf16 a[76:79], a[220:223], v[196:199], a[76:79]
    s_nop 3
    v_accvgpr_read_b32 v244, a236
    v_accvgpr_read_b32 v246, a240
    v_accvgpr_read_b32 v248, a244
    v_accvgpr_read_b32 v250, a248
    v_rcp_f32 v244, v244
    v_rcp_f32 v246, v246
    v_rcp_f32 v248, v248
    v_rcp_f32 v250, v250
    v_mov_b32 v200, v236
    v_xor_b32 v201, 64, v236
    v_subrev_u32 v237, 24576, v237
    v_subrev_u32 v238, 24576, v238
    v_subrev_u32 v239, 24576, v239
    s_mov_b32 s38, s29
    v_pk_mul_f32 v[64:65], v[64:65], v[244:245] op_sel_hi:[1,0]
    v_pk_mul_f32 v[66:67], v[66:67], v[244:245] op_sel_hi:[1,0]
    v_pk_mul_f32 v[80:81], v[80:81], v[244:245] op_sel_hi:[1,0]
    v_pk_mul_f32 v[82:83], v[82:83], v[244:245] op_sel_hi:[1,0]
    v_cvt_pk_bf16_f32 v32, v64, v65
    v_cvt_pk_bf16_f32 v33, v66, v67
    v_cvt_pk_bf16_f32 v34, v80, v81
    v_cvt_pk_bf16_f32 v35, v82, v83
    ds_write_b128 v200, v[32:35]
    v_pk_mul_f32 v[96:97], v[96:97], v[244:245] op_sel_hi:[1,0]
    v_pk_mul_f32 v[98:99], v[98:99], v[244:245] op_sel_hi:[1,0]
    v_pk_mul_f32 v[112:113], v[112:113], v[244:245] op_sel_hi:[1,0]
    v_pk_mul_f32 v[114:115], v[114:115], v[244:245] op_sel_hi:[1,0]
    v_cvt_pk_bf16_f32 v36, v96, v97
    v_cvt_pk_bf16_f32 v37, v98, v99
    v_cvt_pk_bf16_f32 v38, v112, v113
    v_cvt_pk_bf16_f32 v39, v114, v115
    ds_write_b128 v201, v[36:39]
    v_accvgpr_read_b32 v60, a0
    v_accvgpr_read_b32 v61, a1
    v_accvgpr_read_b32 v62, a2
    v_accvgpr_read_b32 v63, a3
    v_pk_mul_f32 v[128:129], v[128:129], v[244:245] op_sel_hi:[1,0]
    v_pk_mul_f32 v[130:131], v[130:131], v[244:245] op_sel_hi:[1,0]
    v_pk_mul_f32 v[144:145], v[144:145], v[244:245] op_sel_hi:[1,0]
    v_pk_mul_f32 v[146:147], v[146:147], v[244:245] op_sel_hi:[1,0]
    v_cvt_pk_bf16_f32 v40, v128, v129
    v_cvt_pk_bf16_f32 v41, v130, v131
    v_cvt_pk_bf16_f32 v42, v144, v145
    v_cvt_pk_bf16_f32 v43, v146, v147
    ds_write_b128 v200, v[40:43] offset:128
    v_pk_mul_f32 v[160:161], v[160:161], v[244:245] op_sel_hi:[1,0]
    v_pk_mul_f32 v[162:163], v[162:163], v[244:245] op_sel_hi:[1,0]
    v_pk_mul_f32 v[60:61], v[60:61], v[244:245] op_sel_hi:[1,0]
    v_pk_mul_f32 v[62:63], v[62:63], v[244:245] op_sel_hi:[1,0]
    v_cvt_pk_bf16_f32 v44, v160, v161
    v_cvt_pk_bf16_f32 v45, v162, v163
    v_cvt_pk_bf16_f32 v46, v60, v61
    v_cvt_pk_bf16_f32 v47, v62, v63
    ds_write_b128 v201, v[44:47] offset:128
    v_accvgpr_read_b32 v48, a16
    v_accvgpr_read_b32 v49, a17
    v_accvgpr_read_b32 v50, a18
    v_accvgpr_read_b32 v51, a19
    v_accvgpr_read_b32 v52, a32
    v_accvgpr_read_b32 v53, a33
    v_accvgpr_read_b32 v54, a34
    v_accvgpr_read_b32 v55, a35
    v_accvgpr_read_b32 v56, a48
    v_accvgpr_read_b32 v57, a49
    v_accvgpr_read_b32 v58, a50
    v_accvgpr_read_b32 v59, a51
    v_accvgpr_read_b32 v60, a64
    v_accvgpr_read_b32 v61, a65
    v_accvgpr_read_b32 v62, a66
    v_accvgpr_read_b32 v63, a67
    v_pk_mul_f32 v[48:49], v[48:49], v[244:245] op_sel_hi:[1,0]
    v_pk_mul_f32 v[50:51], v[50:51], v[244:245] op_sel_hi:[1,0]
    v_pk_mul_f32 v[52:53], v[52:53], v[244:245] op_sel_hi:[1,0]
    v_pk_mul_f32 v[54:55], v[54:55], v[244:245] op_sel_hi:[1,0]
    v_cvt_pk_bf16_f32 v32, v48, v49
    v_cvt_pk_bf16_f32 v33, v50, v51
    v_cvt_pk_bf16_f32 v34, v52, v53
    v_cvt_pk_bf16_f32 v35, v54, v55
    ds_write_b128 v200, v[32:35] offset:256
    v_pk_mul_f32 v[56:57], v[56:57], v[244:245] op_sel_hi:[1,0]
    v_pk_mul_f32 v[58:59], v[58:59], v[244:245] op_sel_hi:[1,0]
    v_pk_mul_f32 v[60:61], v[60:61], v[244:245] op_sel_hi:[1,0]
    v_pk_mul_f32 v[62:63], v[62:63], v[244:245] op_sel_hi:[1,0]
    v_cvt_pk_bf16_f32 v36, v56, v57
    v_cvt_pk_bf16_f32 v37, v58, v59
    v_cvt_pk_bf16_f32 v38, v60, v61
    v_cvt_pk_bf16_f32 v39, v62, v63
    ds_write_b128 v201, v[36:39] offset:256
    ds_read_b128 v[0:3], v237
    ds_read_b128 v[4:7], v238
    ds_read_b128 v[8:11], v239
    ds_read_b128 v[12:15], v237 offset:3072
    ds_read_b128 v[16:19], v238 offset:3072
    ds_read_b128 v[20:23], v239 offset:3072
    v_pk_mul_f32 v[68:69], v[68:69], v[246:247] op_sel_hi:[1,0]
    v_pk_mul_f32 v[70:71], v[70:71], v[246:247] op_sel_hi:[1,0]
    v_pk_mul_f32 v[84:85], v[84:85], v[246:247] op_sel_hi:[1,0]
    v_pk_mul_f32 v[86:87], v[86:87], v[246:247] op_sel_hi:[1,0]
    v_cvt_pk_bf16_f32 v40, v68, v69
    v_cvt_pk_bf16_f32 v41, v70, v71
    v_cvt_pk_bf16_f32 v42, v84, v85
    v_cvt_pk_bf16_f32 v43, v86, v87
    ds_write_b128 v200, v[40:43] offset:6144
    s_waitcnt lgkmcnt(6)
    buffer_store_dwordx4 v[0:3], v235, s[16:19], s38 offen nt
    v_pk_mul_f32 v[100:101], v[100:101], v[246:247] op_sel_hi:[1,0]
    v_pk_mul_f32 v[102:103], v[102:103], v[246:247] op_sel_hi:[1,0]
    v_pk_mul_f32 v[116:117], v[116:117], v[246:247] op_sel_hi:[1,0]
    v_pk_mul_f32 v[118:119], v[118:119], v[246:247] op_sel_hi:[1,0]
    v_cvt_pk_bf16_f32 v44, v100, v101
    v_cvt_pk_bf16_f32 v45, v102, v103
    v_cvt_pk_bf16_f32 v46, v116, v117
    v_cvt_pk_bf16_f32 v47, v118, v119
    ds_write_b128 v201, v[44:47] offset:6144
    s_waitcnt lgkmcnt(6)
    buffer_store_dwordx4 v[4:7], v235, s[16:19], s38 offen offset:1024 nt
    v_accvgpr_read_b32 v60, a4
    v_accvgpr_read_b32 v61, a5
    v_accvgpr_read_b32 v62, a6
    v_accvgpr_read_b32 v63, a7
    v_pk_mul_f32 v[132:133], v[132:133], v[246:247] op_sel_hi:[1,0]
    v_pk_mul_f32 v[134:135], v[134:135], v[246:247] op_sel_hi:[1,0]
    v_pk_mul_f32 v[148:149], v[148:149], v[246:247] op_sel_hi:[1,0]
    v_pk_mul_f32 v[150:151], v[150:151], v[246:247] op_sel_hi:[1,0]
    v_cvt_pk_bf16_f32 v32, v132, v133
    v_cvt_pk_bf16_f32 v33, v134, v135
    v_cvt_pk_bf16_f32 v34, v148, v149
    v_cvt_pk_bf16_f32 v35, v150, v151
    ds_write_b128 v200, v[32:35] offset:6272
    s_waitcnt lgkmcnt(6)
    buffer_store_dwordx4 v[8:11], v235, s[16:19], s38 offen offset:2048 nt
    s_add_u32 s38, s38, 3072
    v_pk_mul_f32 v[164:165], v[164:165], v[246:247] op_sel_hi:[1,0]
    v_pk_mul_f32 v[166:167], v[166:167], v[246:247] op_sel_hi:[1,0]
    v_pk_mul_f32 v[60:61], v[60:61], v[246:247] op_sel_hi:[1,0]
    v_pk_mul_f32 v[62:63], v[62:63], v[246:247] op_sel_hi:[1,0]
    v_cvt_pk_bf16_f32 v36, v164, v165
    v_cvt_pk_bf16_f32 v37, v166, v167
    v_cvt_pk_bf16_f32 v38, v60, v61
    v_cvt_pk_bf16_f32 v39, v62, v63
    ds_write_b128 v201, v[36:39] offset:6272
    s_waitcnt lgkmcnt(6)
    buffer_store_dwordx4 v[12:15], v235, s[16:19], s38 offen nt
    v_accvgpr_read_b32 v48, a20
    v_accvgpr_read_b32 v49, a21
    v_accvgpr_read_b32 v50, a22
    v_accvgpr_read_b32 v51, a23
    v_accvgpr_read_b32 v52, a36
    v_accvgpr_read_b32 v53, a37
    v_accvgpr_read_b32 v54, a38
    v_accvgpr_read_b32 v55, a39
    v_accvgpr_read_b32 v56, a52
    v_accvgpr_read_b32 v57, a53
    v_accvgpr_read_b32 v58, a54
    v_accvgpr_read_b32 v59, a55
    v_accvgpr_read_b32 v60, a68
    v_accvgpr_read_b32 v61, a69
    v_accvgpr_read_b32 v62, a70
    v_accvgpr_read_b32 v63, a71
    v_pk_mul_f32 v[48:49], v[48:49], v[246:247] op_sel_hi:[1,0]
    v_pk_mul_f32 v[50:51], v[50:51], v[246:247] op_sel_hi:[1,0]
    v_pk_mul_f32 v[52:53], v[52:53], v[246:247] op_sel_hi:[1,0]
    v_pk_mul_f32 v[54:55], v[54:55], v[246:247] op_sel_hi:[1,0]
    v_cvt_pk_bf16_f32 v40, v48, v49
    v_cvt_pk_bf16_f32 v41, v50, v51
    v_cvt_pk_bf16_f32 v42, v52, v53
    v_cvt_pk_bf16_f32 v43, v54, v55
    ds_write_b128 v200, v[40:43] offset:6400
    s_waitcnt lgkmcnt(6)
    buffer_store_dwordx4 v[16:19], v235, s[16:19], s38 offen offset:1024 nt
    v_pk_mul_f32 v[56:57], v[56:57], v[246:247] op_sel_hi:[1,0]
    v_pk_mul_f32 v[58:59], v[58:59], v[246:247] op_sel_hi:[1,0]
    v_pk_mul_f32 v[60:61], v[60:61], v[246:247] op_sel_hi:[1,0]
    v_pk_mul_f32 v[62:63], v[62:63], v[246:247] op_sel_hi:[1,0]
    v_cvt_pk_bf16_f32 v44, v56, v57
    v_cvt_pk_bf16_f32 v45, v58, v59
    v_cvt_pk_bf16_f32 v46, v60, v61
    v_cvt_pk_bf16_f32 v47, v62, v63
    ds_write_b128 v201, v[44:47] offset:6400
    s_waitcnt lgkmcnt(6)
    buffer_store_dwordx4 v[20:23], v235, s[16:19], s38 offen offset:2048 nt
    s_add_u32 s38, s38, 3072
    ds_read_b128 v[0:3], v237 offset:6144
    ds_read_b128 v[4:7], v238 offset:6144
    ds_read_b128 v[8:11], v239 offset:6144
    ds_read_b128 v[12:15], v237 offset:9216
    ds_read_b128 v[16:19], v238 offset:9216
    ds_read_b128 v[20:23], v239 offset:9216
    v_pk_mul_f32 v[72:73], v[72:73], v[248:249] op_sel_hi:[1,0]
    v_pk_mul_f32 v[74:75], v[74:75], v[248:249] op_sel_hi:[1,0]
    v_pk_mul_f32 v[88:89], v[88:89], v[248:249] op_sel_hi:[1,0]
    v_pk_mul_f32 v[90:91], v[90:91], v[248:249] op_sel_hi:[1,0]
    v_cvt_pk_bf16_f32 v32, v72, v73
    v_cvt_pk_bf16_f32 v33, v74, v75
    v_cvt_pk_bf16_f32 v34, v88, v89
    v_cvt_pk_bf16_f32 v35, v90, v91
    ds_write_b128 v200, v[32:35] offset:12288
    s_waitcnt lgkmcnt(6)
    buffer_store_dwordx4 v[0:3], v235, s[16:19], s38 offen nt
    v_pk_mul_f32 v[104:105], v[104:105], v[248:249] op_sel_hi:[1,0]
    v_pk_mul_f32 v[106:107], v[106:107], v[248:249] op_sel_hi:[1,0]
    v_pk_mul_f32 v[120:121], v[120:121], v[248:249] op_sel_hi:[1,0]
    v_pk_mul_f32 v[122:123], v[122:123], v[248:249] op_sel_hi:[1,0]
    v_cvt_pk_bf16_f32 v36, v104, v105
    v_cvt_pk_bf16_f32 v37, v106, v107
    v_cvt_pk_bf16_f32 v38, v120, v121
    v_cvt_pk_bf16_f32 v39, v122, v123
    ds_write_b128 v201, v[36:39] offset:12288
    s_waitcnt lgkmcnt(6)
    buffer_store_dwordx4 v[4:7], v235, s[16:19], s38 offen offset:1024 nt
    v_accvgpr_read_b32 v60, a8
    v_accvgpr_read_b32 v61, a9
    v_accvgpr_read_b32 v62, a10
    v_accvgpr_read_b32 v63, a11
    v_pk_mul_f32 v[136:137], v[136:137], v[248:249] op_sel_hi:[1,0]
    v_pk_mul_f32 v[138:139], v[138:139], v[248:249] op_sel_hi:[1,0]
    v_pk_mul_f32 v[152:153], v[152:153], v[248:249] op_sel_hi:[1,0]
    v_pk_mul_f32 v[154:155], v[154:155], v[248:249] op_sel_hi:[1,0]
    v_cvt_pk_bf16_f32 v40, v136, v137
    v_cvt_pk_bf16_f32 v41, v138, v139
    v_cvt_pk_bf16_f32 v42, v152, v153
    v_cvt_pk_bf16_f32 v43, v154, v155
    ds_write_b128 v200, v[40:43] offset:12416
    s_waitcnt lgkmcnt(6)
    buffer_store_dwordx4 v[8:11], v235, s[16:19], s38 offen offset:2048 nt
    s_add_u32 s38, s38, 3072
    v_pk_mul_f32 v[168:169], v[168:169], v[248:249] op_sel_hi:[1,0]
    v_pk_mul_f32 v[170:171], v[170:171], v[248:249] op_sel_hi:[1,0]
    v_pk_mul_f32 v[60:61], v[60:61], v[248:249] op_sel_hi:[1,0]
    v_pk_mul_f32 v[62:63], v[62:63], v[248:249] op_sel_hi:[1,0]
    v_cvt_pk_bf16_f32 v44, v168, v169
    v_cvt_pk_bf16_f32 v45, v170, v171
    v_cvt_pk_bf16_f32 v46, v60, v61
    v_cvt_pk_bf16_f32 v47, v62, v63
    ds_write_b128 v201, v[44:47] offset:12416
    s_waitcnt lgkmcnt(6)
    buffer_store_dwordx4 v[12:15], v235, s[16:19], s38 offen nt
    v_accvgpr_read_b32 v48, a24
    v_accvgpr_read_b32 v49, a25
    v_accvgpr_read_b32 v50, a26
    v_accvgpr_read_b32 v51, a27
    v_accvgpr_read_b32 v52, a40
    v_accvgpr_read_b32 v53, a41
    v_accvgpr_read_b32 v54, a42
    v_accvgpr_read_b32 v55, a43
    v_accvgpr_read_b32 v56, a56
    v_accvgpr_read_b32 v57, a57
    v_accvgpr_read_b32 v58, a58
    v_accvgpr_read_b32 v59, a59
    v_accvgpr_read_b32 v60, a72
    v_accvgpr_read_b32 v61, a73
    v_accvgpr_read_b32 v62, a74
    v_accvgpr_read_b32 v63, a75
    v_pk_mul_f32 v[48:49], v[48:49], v[248:249] op_sel_hi:[1,0]
    v_pk_mul_f32 v[50:51], v[50:51], v[248:249] op_sel_hi:[1,0]
    v_pk_mul_f32 v[52:53], v[52:53], v[248:249] op_sel_hi:[1,0]
    v_pk_mul_f32 v[54:55], v[54:55], v[248:249] op_sel_hi:[1,0]
    v_cvt_pk_bf16_f32 v32, v48, v49
    v_cvt_pk_bf16_f32 v33, v50, v51
    v_cvt_pk_bf16_f32 v34, v52, v53
    v_cvt_pk_bf16_f32 v35, v54, v55
    ds_write_b128 v200, v[32:35] offset:12544
    s_waitcnt lgkmcnt(6)
    buffer_store_dwordx4 v[16:19], v235, s[16:19], s38 offen offset:1024 nt
    v_pk_mul_f32 v[56:57], v[56:57], v[248:249] op_sel_hi:[1,0]
    v_pk_mul_f32 v[58:59], v[58:59], v[248:249] op_sel_hi:[1,0]
    v_pk_mul_f32 v[60:61], v[60:61], v[248:249] op_sel_hi:[1,0]
    v_pk_mul_f32 v[62:63], v[62:63], v[248:249] op_sel_hi:[1,0]
    v_cvt_pk_bf16_f32 v36, v56, v57
    v_cvt_pk_bf16_f32 v37, v58, v59
    v_cvt_pk_bf16_f32 v38, v60, v61
    v_cvt_pk_bf16_f32 v39, v62, v63
    ds_write_b128 v201, v[36:39] offset:12544
    s_waitcnt lgkmcnt(6)
    buffer_store_dwordx4 v[20:23], v235, s[16:19], s38 offen offset:2048 nt
    s_add_u32 s38, s38, 3072
    ds_read_b128 v[0:3], v237 offset:12288
    ds_read_b128 v[4:7], v238 offset:12288
    ds_read_b128 v[8:11], v239 offset:12288
    ds_read_b128 v[12:15], v237 offset:15360
    ds_read_b128 v[16:19], v238 offset:15360
    ds_read_b128 v[20:23], v239 offset:15360
    v_pk_mul_f32 v[76:77], v[76:77], v[250:251] op_sel_hi:[1,0]
    v_pk_mul_f32 v[78:79], v[78:79], v[250:251] op_sel_hi:[1,0]
    v_pk_mul_f32 v[92:93], v[92:93], v[250:251] op_sel_hi:[1,0]
    v_pk_mul_f32 v[94:95], v[94:95], v[250:251] op_sel_hi:[1,0]
    v_cvt_pk_bf16_f32 v40, v76, v77
    v_cvt_pk_bf16_f32 v41, v78, v79
    v_cvt_pk_bf16_f32 v42, v92, v93
    v_cvt_pk_bf16_f32 v43, v94, v95
    ds_write_b128 v200, v[40:43] offset:18432
    s_waitcnt lgkmcnt(6)
    buffer_store_dwordx4 v[0:3], v235, s[16:19], s38 offen nt
    v_pk_mul_f32 v[108:109], v[108:109], v[250:251] op_sel_hi:[1,0]
    v_pk_mul_f32 v[110:111], v[110:111], v[250:251] op_sel_hi:[1,0]
    v_pk_mul_f32 v[124:125], v[124:125], v[250:251] op_sel_hi:[1,0]
    v_pk_mul_f32 v[126:127], v[126:127], v[250:251] op_sel_hi:[1,0]
    v_cvt_pk_bf16_f32 v44, v108, v109
    v_cvt_pk_bf16_f32 v45, v110, v111
    v_cvt_pk_bf16_f32 v46, v124, v125
    v_cvt_pk_bf16_f32 v47, v126, v127
    ds_write_b128 v201, v[44:47] offset:18432
    s_waitcnt lgkmcnt(6)
    buffer_store_dwordx4 v[4:7], v235, s[16:19], s38 offen offset:1024 nt
    v_accvgpr_read_b32 v60, a12
    v_accvgpr_read_b32 v61, a13
    v_accvgpr_read_b32 v62, a14
    v_accvgpr_read_b32 v63, a15
    v_pk_mul_f32 v[140:141], v[140:141], v[250:251] op_sel_hi:[1,0]
    v_pk_mul_f32 v[142:143], v[142:143], v[250:251] op_sel_hi:[1,0]
    v_pk_mul_f32 v[156:157], v[156:157], v[250:251] op_sel_hi:[1,0]
    v_pk_mul_f32 v[158:159], v[158:159], v[250:251] op_sel_hi:[1,0]
    v_cvt_pk_bf16_f32 v32, v140, v141
    v_cvt_pk_bf16_f32 v33, v142, v143
    v_cvt_pk_bf16_f32 v34, v156, v157
    v_cvt_pk_bf16_f32 v35, v158, v159
    ds_write_b128 v200, v[32:35] offset:18560
    s_waitcnt lgkmcnt(6)
    buffer_store_dwordx4 v[8:11], v235, s[16:19], s38 offen offset:2048 nt
    s_add_u32 s38, s38, 3072
    v_pk_mul_f32 v[172:173], v[172:173], v[250:251] op_sel_hi:[1,0]
    v_pk_mul_f32 v[174:175], v[174:175], v[250:251] op_sel_hi:[1,0]
    v_pk_mul_f32 v[60:61], v[60:61], v[250:251] op_sel_hi:[1,0]
    v_pk_mul_f32 v[62:63], v[62:63], v[250:251] op_sel_hi:[1,0]
    v_cvt_pk_bf16_f32 v36, v172, v173
    v_cvt_pk_bf16_f32 v37, v174, v175
    v_cvt_pk_bf16_f32 v38, v60, v61
    v_cvt_pk_bf16_f32 v39, v62, v63
    ds_write_b128 v201, v[36:39] offset:18560
    s_waitcnt lgkmcnt(6)
    buffer_store_dwordx4 v[12:15], v235, s[16:19], s38 offen nt
    v_accvgpr_read_b32 v48, a28
    v_accvgpr_read_b32 v49, a29
    v_accvgpr_read_b32 v50, a30
    v_accvgpr_read_b32 v51, a31
    v_accvgpr_read_b32 v52, a44
    v_accvgpr_read_b32 v53, a45
    v_accvgpr_read_b32 v54, a46
    v_accvgpr_read_b32 v55, a47
    v_accvgpr_read_b32 v56, a60
    v_accvgpr_read_b32 v57, a61
    v_accvgpr_read_b32 v58, a62
    v_accvgpr_read_b32 v59, a63
    v_accvgpr_read_b32 v60, a76
    v_accvgpr_read_b32 v61, a77
    v_accvgpr_read_b32 v62, a78
    v_accvgpr_read_b32 v63, a79
    v_pk_mul_f32 v[48:49], v[48:49], v[250:251] op_sel_hi:[1,0]
    v_pk_mul_f32 v[50:51], v[50:51], v[250:251] op_sel_hi:[1,0]
    v_pk_mul_f32 v[52:53], v[52:53], v[250:251] op_sel_hi:[1,0]
    v_pk_mul_f32 v[54:55], v[54:55], v[250:251] op_sel_hi:[1,0]
    v_cvt_pk_bf16_f32 v40, v48, v49
    v_cvt_pk_bf16_f32 v41, v50, v51
    v_cvt_pk_bf16_f32 v42, v52, v53
    v_cvt_pk_bf16_f32 v43, v54, v55
    ds_write_b128 v200, v[40:43] offset:18688
    s_waitcnt lgkmcnt(6)
    buffer_store_dwordx4 v[16:19], v235, s[16:19], s38 offen offset:1024 nt
    v_pk_mul_f32 v[56:57], v[56:57], v[250:251] op_sel_hi:[1,0]
    v_pk_mul_f32 v[58:59], v[58:59], v[250:251] op_sel_hi:[1,0]
    v_pk_mul_f32 v[60:61], v[60:61], v[250:251] op_sel_hi:[1,0]
    v_pk_mul_f32 v[62:63], v[62:63], v[250:251] op_sel_hi:[1,0]
    v_cvt_pk_bf16_f32 v44, v56, v57
    v_cvt_pk_bf16_f32 v45, v58, v59
    v_cvt_pk_bf16_f32 v46, v60, v61
    v_cvt_pk_bf16_f32 v47, v62, v63
    ds_write_b128 v201, v[44:47] offset:18688
    s_waitcnt lgkmcnt(6)
    buffer_store_dwordx4 v[20:23], v235, s[16:19], s38 offen offset:2048 nt
    s_add_u32 s38, s38, 3072
    ds_read_b128 v[0:3], v237 offset:18432
    ds_read_b128 v[4:7], v238 offset:18432
    ds_read_b128 v[8:11], v239 offset:18432
    ds_read_b128 v[12:15], v237 offset:21504
    ds_read_b128 v[16:19], v238 offset:21504
    ds_read_b128 v[20:23], v239 offset:21504
    s_waitcnt lgkmcnt(5)
    buffer_store_dwordx4 v[0:3], v235, s[16:19], s38 offen nt
    s_waitcnt lgkmcnt(4)
    buffer_store_dwordx4 v[4:7], v235, s[16:19], s38 offen offset:1024 nt
    s_waitcnt lgkmcnt(3)
    buffer_store_dwordx4 v[8:11], v235, s[16:19], s38 offen offset:2048 nt
    s_add_u32 s38, s38, 3072
    s_waitcnt lgkmcnt(2)
    buffer_store_dwordx4 v[12:15], v235, s[16:19], s38 offen nt
    s_waitcnt lgkmcnt(1)
    buffer_store_dwordx4 v[16:19], v235, s[16:19], s38 offen offset:1024 nt
    s_waitcnt lgkmcnt(0)
    buffer_store_dwordx4 v[20:23], v235, s[16:19], s38 offen offset:2048 nt
    s_add_u32 s38, s38, 3072
    s_waitcnt vmcnt(0)
L_end:
    s_endpgm
L_rare_b0e:
L_rare_ste:
L_rare_b7e:
L_rare_ble:
    v_max3_f32 v240, v0, v1, v2
    v_max3_f32 v240, v240, v3, v16
    v_max3_f32 v240, v240, v17, v18
    v_max_f32 v240, v240, v19
    v_max3_f32 v241, v4, v5, v6
    v_max3_f32 v241, v241, v7, v20
    v_max3_f32 v241, v241, v21, v22
    v_max_f32 v241, v241, v23
    v_max3_f32 v242, v8, v9, v10
    v_max3_f32 v242, v242, v11, v24
    v_max3_f32 v242, v242, v25, v26
    v_max_f32 v242, v242, v27
    v_max3_f32 v243, v12, v13, v14
    v_max3_f32 v243, v243, v15, v28
    v_max3_f32 v243, v243, v29, v30
    v_max_f32 v243, v243, v31
    s_nop 1
    v_permlane32_swap_b32 v240, v241
    v_permlane32_swap_b32 v242, v243
    v_max_f32 v240, v240, v241
    v_max_f32 v242, v242, v243
    s_nop 1
    v_permlane16_swap_b32 v240, v242
    v_max_f32 v240, v240, v242
    v_add_f32 v204, 0x41000000, v240
    v_max_f32 v204, 0, v204
    v_mov_b32 v206, v204
    s_nop 1
    v_permlane16_swap_b32 v204, v206
    v_mov_b32 v205, v204
    v_mov_b32 v207, v206
    s_nop 0
    v_permlane32_swap_b32 v204, v205
    v_permlane32_swap_b32 v206, v207
    v_sub_f32 v240, 0, v204
    v_exp_f32 v240, v240
    s_nop 0
    v_sub_f32 v222, v222, v204
    v_mul_f32 v64, v64, v240
    v_mul_f32 v65, v65, v240
    v_mul_f32 v66, v66, v240
    v_mul_f32 v67, v67, v240
    v_mul_f32 v80, v80, v240
    v_mul_f32 v81, v81, v240
    v_mul_f32 v82, v82, v240
    v_mul_f32 v83, v83, v240
    v_mul_f32 v96, v96, v240
    v_mul_f32 v97, v97, v240
    v_mul_f32 v98, v98, v240
    v_mul_f32 v99, v99, v240
    v_mul_f32 v112, v112, v240
    v_mul_f32 v113, v113, v240
    v_mul_f32 v114, v114, v240
    v_mul_f32 v115, v115, v240
    v_mul_f32 v128, v128, v240
    v_mul_f32 v129, v129, v240
    v_mul_f32 v130, v130, v240
    v_mul_f32 v131, v131, v240
    v_mul_f32 v144, v144, v240
    v_mul_f32 v145, v145, v240
    v_mul_f32 v146, v146, v240
    v_mul_f32 v147, v147, v240
    v_mul_f32 v160, v160, v240
    v_mul_f32 v161, v161, v240
    v_mul_f32 v162, v162, v240
    v_mul_f32 v163, v163, v240
    v_accvgpr_read_b32 v202, a0
    v_mul_f32 v202, v202, v240
    v_accvgpr_write_b32 a0, v202
    v_accvgpr_read_b32 v202, a1
    v_mul_f32 v202, v202, v240
    v_accvgpr_write_b32 a1, v202
    v_accvgpr_read_b32 v202, a2
    v_mul_f32 v202, v202, v240
    v_accvgpr_write_b32 a2, v202
    v_accvgpr_read_b32 v202, a3
    v_mul_f32 v202, v202, v240
    v_accvgpr_write_b32 a3, v202
    v_accvgpr_read_b32 v202, a16
    v_mul_f32 v202, v202, v240
    v_accvgpr_write_b32 a16, v202
    v_accvgpr_read_b32 v202, a17
    v_mul_f32 v202, v202, v240
    v_accvgpr_write_b32 a17, v202
    v_accvgpr_read_b32 v202, a18
    v_mul_f32 v202, v202, v240
    v_accvgpr_write_b32 a18, v202
    v_accvgpr_read_b32 v202, a19
    v_mul_f32 v202, v202, v240
    v_accvgpr_write_b32 a19, v202
    v_accvgpr_read_b32 v202, a32
    v_mul_f32 v202, v202, v240
    v_accvgpr_write_b32 a32, v202
    v_accvgpr_read_b32 v202, a33
    v_mul_f32 v202, v202, v240
    v_accvgpr_write_b32 a33, v202
    v_accvgpr_read_b32 v202, a34
    v_mul_f32 v202, v202, v240
    v_accvgpr_write_b32 a34, v202
    v_accvgpr_read_b32 v202, a35
    v_mul_f32 v202, v202, v240
    v_accvgpr_write_b32 a35, v202
    v_accvgpr_read_b32 v202, a48
    v_mul_f32 v202, v202, v240
    v_accvgpr_write_b32 a48, v202
    v_accvgpr_read_b32 v202, a49
    v_mul_f32 v202, v202, v240
    v_accvgpr_write_b32 a49, v202
    v_accvgpr_read_b32 v202, a50
    v_mul_f32 v202, v202, v240
    v_accvgpr_write_b32 a50, v202
    v_accvgpr_read_b32 v202, a51
    v_mul_f32 v202, v202, v240
    v_accvgpr_write_b32 a51, v202
    v_accvgpr_read_b32 v202, a64
    v_mul_f32 v202, v202, v240
    v_accvgpr_write_b32 a64, v202
    v_accvgpr_read_b32 v202, a65
    v_mul_f32 v202, v202, v240
    v_accvgpr_write_b32 a65, v202
    v_accvgpr_read_b32 v202, a66
    v_mul_f32 v202, v202, v240
    v_accvgpr_write_b32 a66, v202
    v_accvgpr_read_b32 v202, a67
    v_mul_f32 v202, v202, v240
    v_accvgpr_write_b32 a67, v202
    v_accvgpr_read_b32 v202, a236
    v_mul_f32 v202, v202, v240
    v_accvgpr_write_b32 a236, v202
    v_accvgpr_read_b32 v202, a237
    v_mul_f32 v202, v202, v240
    v_accvgpr_write_b32 a237, v202
    v_accvgpr_read_b32 v202, a238
    v_mul_f32 v202, v202, v240
    v_accvgpr_write_b32 a238, v202
    v_accvgpr_read_b32 v202, a239
    v_mul_f32 v202, v202, v240
    v_accvgpr_write_b32 a239, v202
    v_sub_f32 v241, 0, v205
    v_exp_f32 v241, v241
    s_nop 0
    v_sub_f32 v223, v223, v205
    v_mul_f32 v68, v68, v241
    v_mul_f32 v69, v69, v241
    v_mul_f32 v70, v70, v241
    v_mul_f32 v71, v71, v241
    v_mul_f32 v84, v84, v241
    v_mul_f32 v85, v85, v241
    v_mul_f32 v86, v86, v241
    v_mul_f32 v87, v87, v241
    v_mul_f32 v100, v100, v241
    v_mul_f32 v101, v101, v241
    v_mul_f32 v102, v102, v241
    v_mul_f32 v103, v103, v241
    v_mul_f32 v116, v116, v241
    v_mul_f32 v117, v117, v241
    v_mul_f32 v118, v118, v241
    v_mul_f32 v119, v119, v241
    v_mul_f32 v132, v132, v241
    v_mul_f32 v133, v133, v241
    v_mul_f32 v134, v134, v241
    v_mul_f32 v135, v135, v241
    v_mul_f32 v148, v148, v241
    v_mul_f32 v149, v149, v241
    v_mul_f32 v150, v150, v241
    v_mul_f32 v151, v151, v241
    v_mul_f32 v164, v164, v241
    v_mul_f32 v165, v165, v241
    v_mul_f32 v166, v166, v241
    v_mul_f32 v167, v167, v241
    v_accvgpr_read_b32 v202, a4
    v_mul_f32 v202, v202, v241
    v_accvgpr_write_b32 a4, v202
    v_accvgpr_read_b32 v202, a5
    v_mul_f32 v202, v202, v241
    v_accvgpr_write_b32 a5, v202
    v_accvgpr_read_b32 v202, a6
    v_mul_f32 v202, v202, v241
    v_accvgpr_write_b32 a6, v202
    v_accvgpr_read_b32 v202, a7
    v_mul_f32 v202, v202, v241
    v_accvgpr_write_b32 a7, v202
    v_accvgpr_read_b32 v202, a20
    v_mul_f32 v202, v202, v241
    v_accvgpr_write_b32 a20, v202
    v_accvgpr_read_b32 v202, a21
    v_mul_f32 v202, v202, v241
    v_accvgpr_write_b32 a21, v202
    v_accvgpr_read_b32 v202, a22
    v_mul_f32 v202, v202, v241
    v_accvgpr_write_b32 a22, v202
    v_accvgpr_read_b32 v202, a23
    v_mul_f32 v202, v202, v241
    v_accvgpr_write_b32 a23, v202
    v_accvgpr_read_b32 v202, a36
    v_mul_f32 v202, v202, v241
    v_accvgpr_write_b32 a36, v202
    v_accvgpr_read_b32 v202, a37
    v_mul_f32 v202, v202, v241
    v_accvgpr_write_b32 a37, v202
    v_accvgpr_read_b32 v202, a38
    v_mul_f32 v202, v202, v241
    v_accvgpr_write_b32 a38, v202
    v_accvgpr_read_b32 v202, a39
    v_mul_f32 v202, v202, v241
    v_accvgpr_write_b32 a39, v202
    v_accvgpr_read_b32 v202, a52
    v_mul_f32 v202, v202, v241
    v_accvgpr_write_b32 a52, v202
    v_accvgpr_read_b32 v202, a53
    v_mul_f32 v202, v202, v241
    v_accvgpr_write_b32 a53, v202
    v_accvgpr_read_b32 v202, a54
    v_mul_f32 v202, v202, v241
    v_accvgpr_write_b32 a54, v202
    v_accvgpr_read_b32 v202, a55
    v_mul_f32 v202, v202, v241
    v_accvgpr_write_b32 a55, v202
    v_accvgpr_read_b32 v202, a68
    v_mul_f32 v202, v202, v241
    v_accvgpr_write_b32 a68, v202
    v_accvgpr_read_b32 v202, a69
    v_mul_f32 v202, v202, v241
    v_accvgpr_write_b32 a69, v202
    v_accvgpr_read_b32 v202, a70
    v_mul_f32 v202, v202, v241
    v_accvgpr_write_b32 a70, v202
    v_accvgpr_read_b32 v202, a71
    v_mul_f32 v202, v202, v241
    v_accvgpr_write_b32 a71, v202
    v_accvgpr_read_b32 v202, a240
    v_mul_f32 v202, v202, v241
    v_accvgpr_write_b32 a240, v202
    v_accvgpr_read_b32 v202, a241
    v_mul_f32 v202, v202, v241
    v_accvgpr_write_b32 a241, v202
    v_accvgpr_read_b32 v202, a242
    v_mul_f32 v202, v202, v241
    v_accvgpr_write_b32 a242, v202
    v_accvgpr_read_b32 v202, a243
    v_mul_f32 v202, v202, v241
    v_accvgpr_write_b32 a243, v202
    v_sub_f32 v242, 0, v206
    v_exp_f32 v242, v242
    s_nop 0
    v_sub_f32 v224, v224, v206
    v_mul_f32 v72, v72, v242
    v_mul_f32 v73, v73, v242
    v_mul_f32 v74, v74, v242
    v_mul_f32 v75, v75, v242
    v_mul_f32 v88, v88, v242
    v_mul_f32 v89, v89, v242
    v_mul_f32 v90, v90, v242
    v_mul_f32 v91, v91, v242
    v_mul_f32 v104, v104, v242
    v_mul_f32 v105, v105, v242
    v_mul_f32 v106, v106, v242
    v_mul_f32 v107, v107, v242
    v_mul_f32 v120, v120, v242
    v_mul_f32 v121, v121, v242
    v_mul_f32 v122, v122, v242
    v_mul_f32 v123, v123, v242
    v_mul_f32 v136, v136, v242
    v_mul_f32 v137, v137, v242
    v_mul_f32 v138, v138, v242
    v_mul_f32 v139, v139, v242
    v_mul_f32 v152, v152, v242
    v_mul_f32 v153, v153, v242
    v_mul_f32 v154, v154, v242
    v_mul_f32 v155, v155, v242
    v_mul_f32 v168, v168, v242
    v_mul_f32 v169, v169, v242
    v_mul_f32 v170, v170, v242
    v_mul_f32 v171, v171, v242
    v_accvgpr_read_b32 v202, a8
    v_mul_f32 v202, v202, v242
    v_accvgpr_write_b32 a8, v202
    v_accvgpr_read_b32 v202, a9
    v_mul_f32 v202, v202, v242
    v_accvgpr_write_b32 a9, v202
    v_accvgpr_read_b32 v202, a10
    v_mul_f32 v202, v202, v242
    v_accvgpr_write_b32 a10, v202
    v_accvgpr_read_b32 v202, a11
    v_mul_f32 v202, v202, v242
    v_accvgpr_write_b32 a11, v202
    v_accvgpr_read_b32 v202, a24
    v_mul_f32 v202, v202, v242
    v_accvgpr_write_b32 a24, v202
    v_accvgpr_read_b32 v202, a25
    v_mul_f32 v202, v202, v242
    v_accvgpr_write_b32 a25, v202
    v_accvgpr_read_b32 v202, a26
    v_mul_f32 v202, v202, v242
    v_accvgpr_write_b32 a26, v202
    v_accvgpr_read_b32 v202, a27
    v_mul_f32 v202, v202, v242
    v_accvgpr_write_b32 a27, v202
    v_accvgpr_read_b32 v202, a40
    v_mul_f32 v202, v202, v242
    v_accvgpr_write_b32 a40, v202
    v_accvgpr_read_b32 v202, a41
    v_mul_f32 v202, v202, v242
    v_accvgpr_write_b32 a41, v202
    v_accvgpr_read_b32 v202, a42
    v_mul_f32 v202, v202, v242
    v_accvgpr_write_b32 a42, v202
    v_accvgpr_read_b32 v202, a43
    v_mul_f32 v202, v202, v242
    v_accvgpr_write_b32 a43, v202
    v_accvgpr_read_b32 v202, a56
    v_mul_f32 v202, v202, v242
    v_accvgpr_write_b32 a56, v202
    v_accvgpr_read_b32 v202, a57
    v_mul_f32 v202, v202, v242
    v_accvgpr_write_b32 a57, v202
    v_accvgpr_read_b32 v202, a58
    v_mul_f32 v202, v202, v242
    v_accvgpr_write_b32 a58, v202
    v_accvgpr_read_b32 v202, a59
    v_mul_f32 v202, v202, v242
    v_accvgpr_write_b32 a59, v202
    v_accvgpr_read_b32 v202, a72
    v_mul_f32 v202, v202, v242
    v_accvgpr_write_b32 a72, v202
    v_accvgpr_read_b32 v202, a73
    v_mul_f32 v202, v202, v242
    v_accvgpr_write_b32 a73, v202
    v_accvgpr_read_b32 v202, a74
    v_mul_f32 v202, v202, v242
    v_accvgpr_write_b32 a74, v202
    v_accvgpr_read_b32 v202, a75
    v_mul_f32 v202, v202, v242
    v_accvgpr_write_b32 a75, v202
    v_accvgpr_read_b32 v202, a244
    v_mul_f32 v202, v202, v242
    v_accvgpr_write_b32 a244, v202
    v_accvgpr_read_b32 v202, a245
    v_mul_f32 v202, v202, v242
    v_accvgpr_write_b32 a245, v202
    v_accvgpr_read_b32 v202, a246
    v_mul_f32 v202, v202, v242
    v_accvgpr_write_b32 a246, v202
    v_accvgpr_read_b32 v202, a247
    v_mul_f32 v202, v202, v242
    v_accvgpr_write_b32 a247, v202
    v_sub_f32 v243, 0, v207
    v_exp_f32 v243, v243
    s_nop 0
    v_sub_f32 v225, v225, v207
    v_mul_f32 v76, v76, v243
    v_mul_f32 v77, v77, v243
    v_mul_f32 v78, v78, v243
    v_mul_f32 v79, v79, v243
    v_mul_f32 v92, v92, v243
    v_mul_f32 v93, v93, v243
    v_mul_f32 v94, v94, v243
    v_mul_f32 v95, v95, v243
    v_mul_f32 v108, v108, v243
    v_mul_f32 v109, v109, v243
    v_mul_f32 v110, v110, v243
    v_mul_f32 v111, v111, v243
    v_mul_f32 v124, v124, v243
    v_mul_f32 v125, v125, v243
    v_mul_f32 v126, v126, v243
    v_mul_f32 v127, v127, v243
    v_mul_f32 v140, v140, v243
    v_mul_f32 v141, v141, v243
    v_mul_f32 v142, v142, v243
    v_mul_f32 v143, v143, v243
    v_mul_f32 v156, v156, v243
    v_mul_f32 v157, v157, v243
    v_mul_f32 v158, v158, v243
    v_mul_f32 v159, v159, v243
    v_mul_f32 v172, v172, v243
    v_mul_f32 v173, v173, v243
    v_mul_f32 v174, v174, v243
    v_mul_f32 v175, v175, v243
    v_accvgpr_read_b32 v202, a12
    v_mul_f32 v202, v202, v243
    v_accvgpr_write_b32 a12, v202
    v_accvgpr_read_b32 v202, a13
    v_mul_f32 v202, v202, v243
    v_accvgpr_write_b32 a13, v202
    v_accvgpr_read_b32 v202, a14
    v_mul_f32 v202, v202, v243
    v_accvgpr_write_b32 a14, v202
    v_accvgpr_read_b32 v202, a15
    v_mul_f32 v202, v202, v243
    v_accvgpr_write_b32 a15, v202
    v_accvgpr_read_b32 v202, a28
    v_mul_f32 v202, v202, v243
    v_accvgpr_write_b32 a28, v202
    v_accvgpr_read_b32 v202, a29
    v_mul_f32 v202, v202, v243
    v_accvgpr_write_b32 a29, v202
    v_accvgpr_read_b32 v202, a30
    v_mul_f32 v202, v202, v243
    v_accvgpr_write_b32 a30, v202
    v_accvgpr_read_b32 v202, a31
    v_mul_f32 v202, v202, v243
    v_accvgpr_write_b32 a31, v202
    v_accvgpr_read_b32 v202, a44
    v_mul_f32 v202, v202, v243
    v_accvgpr_write_b32 a44, v202
    v_accvgpr_read_b32 v202, a45
    v_mul_f32 v202, v202, v243
    v_accvgpr_write_b32 a45, v202
    v_accvgpr_read_b32 v202, a46
    v_mul_f32 v202, v202, v243
    v_accvgpr_write_b32 a46, v202
    v_accvgpr_read_b32 v202, a47
    v_mul_f32 v202, v202, v243
    v_accvgpr_write_b32 a47, v202
    v_accvgpr_read_b32 v202, a60
    v_mul_f32 v202, v202, v243
    v_accvgpr_write_b32 a60, v202
    v_accvgpr_read_b32 v202, a61
    v_mul_f32 v202, v202, v243
    v_accvgpr_write_b32 a61, v202
    v_accvgpr_read_b32 v202, a62
    v_mul_f32 v202, v202, v243
    v_accvgpr_write_b32 a62, v202
    v_accvgpr_read_b32 v202, a63
    v_mul_f32 v202, v202, v243
    v_accvgpr_write_b32 a63, v202
    v_accvgpr_read_b32 v202, a76
    v_mul_f32 v202, v202, v243
    v_accvgpr_write_b32 a76, v202
    v_accvgpr_read_b32 v202, a77
    v_mul_f32 v202, v202, v243
    v_accvgpr_write_b32 a77, v202
    v_accvgpr_read_b32 v202, a78
    v_mul_f32 v202, v202, v243
    v_accvgpr_write_b32 a78, v202
    v_accvgpr_read_b32 v202, a79
    v_mul_f32 v202, v202, v243
    v_accvgpr_write_b32 a79, v202
    v_accvgpr_read_b32 v202, a248
    v_mul_f32 v202, v202, v243
    v_accvgpr_write_b32 a248, v202
    v_accvgpr_read_b32 v202, a249
    v_mul_f32 v202, v202, v243
    v_accvgpr_write_b32 a249, v202
    v_accvgpr_read_b32 v202, a250
    v_mul_f32 v202, v202, v243
    v_accvgpr_write_b32 a250, v202
    v_accvgpr_read_b32 v202, a251
    v_mul_f32 v202, v202, v243
    v_accvgpr_write_b32 a251, v202
    v_sub_f32 v0, v0, v204
    v_sub_f32 v1, v1, v204
    v_sub_f32 v2, v2, v204
    v_sub_f32 v3, v3, v204
    v_sub_f32 v16, v16, v204
    v_sub_f32 v17, v17, v204
    v_sub_f32 v18, v18, v204
    v_sub_f32 v19, v19, v204
    v_exp_f32 v202, v0
    v_exp_f32 v203, v1
    s_nop 0
    v_cvt_pk_bf16_f32 v176, v202, v203
    v_exp_f32 v202, v2
    v_exp_f32 v203, v3
    s_nop 0
    v_cvt_pk_bf16_f32 v177, v202, v203
    v_exp_f32 v202, v16
    v_exp_f32 v203, v17
    s_nop 0
    v_cvt_pk_bf16_f32 v178, v202, v203
    v_exp_f32 v202, v18
    v_exp_f32 v203, v19
    s_nop 0
    v_cvt_pk_bf16_f32 v179, v202, v203
    v_sub_f32 v4, v4, v205
    v_sub_f32 v5, v5, v205
    v_sub_f32 v6, v6, v205
    v_sub_f32 v7, v7, v205
    v_sub_f32 v20, v20, v205
    v_sub_f32 v21, v21, v205
    v_sub_f32 v22, v22, v205
    v_sub_f32 v23, v23, v205
    v_exp_f32 v202, v4
    v_exp_f32 v203, v5
    s_nop 0
    v_cvt_pk_bf16_f32 v184, v202, v203
    v_exp_f32 v202, v6
    v_exp_f32 v203, v7
    s_nop 0
    v_cvt_pk_bf16_f32 v185, v202, v203
    v_exp_f32 v202, v20
    v_exp_f32 v203, v21
    s_nop 0
    v_cvt_pk_bf16_f32 v186, v202, v203
    v_exp_f32 v202, v22
    v_exp_f32 v203, v23
    s_nop 0
    v_cvt_pk_bf16_f32 v187, v202, v203
    v_sub_f32 v8, v8, v206
    v_sub_f32 v9, v9, v206
    v_sub_f32 v10, v10, v206
    v_sub_f32 v11, v11, v206
    v_sub_f32 v24, v24, v206
    v_sub_f32 v25, v25, v206
    v_sub_f32 v26, v26, v206
    v_sub_f32 v27, v27, v206
    v_exp_f32 v202, v8
    v_exp_f32 v203, v9
    s_nop 0
    v_cvt_pk_bf16_f32 v192, v202, v203
    v_exp_f32 v202, v10
    v_exp_f32 v203, v11
    s_nop 0
    v_cvt_pk_bf16_f32 v193, v202, v203
    v_exp_f32 v202, v24
    v_exp_f32 v203, v25
    s_nop 0
    v_cvt_pk_bf16_f32 v194, v202, v203
    v_exp_f32 v202, v26
    v_exp_f32 v203, v27
    s_nop 0
    v_cvt_pk_bf16_f32 v195, v202, v203
    v_sub_f32 v12, v12, v207
    v_sub_f32 v13, v13, v207
    v_sub_f32 v14, v14, v207
    v_sub_f32 v15, v15, v207
    v_sub_f32 v28, v28, v207
    v_sub_f32 v29, v29, v207
    v_sub_f32 v30, v30, v207
    v_sub_f32 v31, v31, v207
    v_exp_f32 v202, v12
    v_exp_f32 v203, v13
    s_nop 0
    v_cvt_pk_bf16_f32 v196, v202, v203
    v_exp_f32 v202, v14
    v_exp_f32 v203, v15
    s_nop 0
    v_cvt_pk_bf16_f32 v197, v202, v203
    v_exp_f32 v202, v28
    v_exp_f32 v203, v29
    s_nop 0
    v_cvt_pk_bf16_f32 v198, v202, v203
    v_exp_f32 v202, v30
    v_exp_f32 v203, v31
    s_nop 0
    v_cvt_pk_bf16_f32 v199, v202, v203
    s_nop 1
    s_cmp_eq_u32 s30, 0
    s_cbranch_scc1 L_ret_b0e
    s_cmp_eq_u32 s30, 7
    s_cbranch_scc1 L_ret_b7e
    s_cmp_eq_u32 s30, 8
    s_cbranch_scc1 L_ret_ble
    s_branch L_ret_ste
L_rare_b0o:
L_rare_sto:
L_rare_b7o:
L_rare_blo:
    v_max3_f32 v240, v32, v33, v34
    v_max3_f32 v240, v240, v35, v48
    v_max3_f32 v240, v240, v49, v50
    v_max_f32 v240, v240, v51
    v_max3_f32 v241, v36, v37, v38
    v_max3_f32 v241, v241, v39, v52
    v_max3_f32 v241, v241, v53, v54
    v_max_f32 v241, v241, v55
    v_max3_f32 v242, v40, v41, v42
    v_max3_f32 v242, v242, v43, v56
    v_max3_f32 v242, v242, v57, v58
    v_max_f32 v242, v242, v59
    v_max3_f32 v243, v44, v45, v46
    v_max3_f32 v243, v243, v47, v60
    v_max3_f32 v243, v243, v61, v62
    v_max_f32 v243, v243, v63
    s_nop 1
    v_permlane32_swap_b32 v240, v241
    v_permlane32_swap_b32 v242, v243
    v_max_f32 v240, v240, v241
    v_max_f32 v242, v242, v243
    s_nop 1
    v_permlane16_swap_b32 v240, v242
    v_max_f32 v240, v240, v242
    v_add_f32 v204, 0x41000000, v240
    v_max_f32 v204, 0, v204
    v_mov_b32 v206, v204
    s_nop 1
    v_permlane16_swap_b32 v204, v206
    v_mov_b32 v205, v204
    v_mov_b32 v207, v206
    s_nop 0
    v_permlane32_swap_b32 v204, v205
    v_permlane32_swap_b32 v206, v207
    v_sub_f32 v240, 0, v204
    v_exp_f32 v240, v240
    s_nop 0
    v_sub_f32 v222, v222, v204
    v_mul_f32 v64, v64, v240
    v_mul_f32 v65, v65, v240
    v_mul_f32 v66, v66, v240
    v_mul_f32 v67, v67, v240
    v_mul_f32 v80, v80, v240
    v_mul_f32 v81, v81, v240
    v_mul_f32 v82, v82, v240
    v_mul_f32 v83, v83, v240
    v_mul_f32 v96, v96, v240
    v_mul_f32 v97, v97, v240
    v_mul_f32 v98, v98, v240
    v_mul_f32 v99, v99, v240
    v_mul_f32 v112, v112, v240
    v_mul_f32 v113, v113, v240
    v_mul_f32 v114, v114, v240
    v_mul_f32 v115, v115, v240
    v_mul_f32 v128, v128, v240
    v_mul_f32 v129, v129, v240
    v_mul_f32 v130, v130, v240
    v_mul_f32 v131, v131, v240
    v_mul_f32 v144, v144, v240
    v_mul_f32 v145, v145, v240
    v_mul_f32 v146, v146, v240
    v_mul_f32 v147, v147, v240
    v_mul_f32 v160, v160, v240
    v_mul_f32 v161, v161, v240
    v_mul_f32 v162, v162, v240
    v_mul_f32 v163, v163, v240
    v_accvgpr_read_b32 v202, a0
    v_mul_f32 v202, v202, v240
    v_accvgpr_write_b32 a0, v202
    v_accvgpr_read_b32 v202, a1
    v_mul_f32 v202, v202, v240
    v_accvgpr_write_b32 a1, v202
    v_accvgpr_read_b32 v202, a2
    v_mul_f32 v202, v202, v240
    v_accvgpr_write_b32 a2, v202
    v_accvgpr_read_b32 v202, a3
    v_mul_f32 v202, v202, v240
    v_accvgpr_write_b32 a3, v202
    v_accvgpr_read_b32 v202, a16
    v_mul_f32 v202, v202, v240
    v_accvgpr_write_b32 a16, v202
    v_accvgpr_read_b32 v202, a17
    v_mul_f32 v202, v202, v240
    v_accvgpr_write_b32 a17, v202
    v_accvgpr_read_b32 v202, a18
    v_mul_f32 v202, v202, v240
    v_accvgpr_write_b32 a18, v202
    v_accvgpr_read_b32 v202, a19
    v_mul_f32 v202, v202, v240
    v_accvgpr_write_b32 a19, v202
    v_accvgpr_read_b32 v202, a32
    v_mul_f32 v202, v202, v240
    v_accvgpr_write_b32 a32, v202
    v_accvgpr_read_b32 v202, a33
    v_mul_f32 v202, v202, v240
    v_accvgpr_write_b32 a33, v202
    v_accvgpr_read_b32 v202, a34
    v_mul_f32 v202, v202, v240
    v_accvgpr_write_b32 a34, v202
    v_accvgpr_read_b32 v202, a35
    v_mul_f32 v202, v202, v240
    v_accvgpr_write_b32 a35, v202
    v_accvgpr_read_b32 v202, a48
    v_mul_f32 v202, v202, v240
    v_accvgpr_write_b32 a48, v202
    v_accvgpr_read_b32 v202, a49
    v_mul_f32 v202, v202, v240
    v_accvgpr_write_b32 a49, v202
    v_accvgpr_read_b32 v202, a50
    v_mul_f32 v202, v202, v240
    v_accvgpr_write_b32 a50, v202
    v_accvgpr_read_b32 v202, a51
    v_mul_f32 v202, v202, v240
    v_accvgpr_write_b32 a51, v202
    v_accvgpr_read_b32 v202, a64
    v_mul_f32 v202, v202, v240
    v_accvgpr_write_b32 a64, v202
    v_accvgpr_read_b32 v202, a65
    v_mul_f32 v202, v202, v240
    v_accvgpr_write_b32 a65, v202
    v_accvgpr_read_b32 v202, a66
    v_mul_f32 v202, v202, v240
    v_accvgpr_write_b32 a66, v202
    v_accvgpr_read_b32 v202, a67
    v_mul_f32 v202, v202, v240
    v_accvgpr_write_b32 a67, v202
    v_accvgpr_read_b32 v202, a236
    v_mul_f32 v202, v202, v240
    v_accvgpr_write_b32 a236, v202
    v_accvgpr_read_b32 v202, a237
    v_mul_f32 v202, v202, v240
    v_accvgpr_write_b32 a237, v202
    v_accvgpr_read_b32 v202, a238
    v_mul_f32 v202, v202, v240
    v_accvgpr_write_b32 a238, v202
    v_accvgpr_read_b32 v202, a239
    v_mul_f32 v202, v202, v240
    v_accvgpr_write_b32 a239, v202
    v_sub_f32 v241, 0, v205
    v_exp_f32 v241, v241
    s_nop 0
    v_sub_f32 v223, v223, v205
    v_mul_f32 v68, v68, v241
    v_mul_f32 v69, v69, v241
    v_mul_f32 v70, v70, v241
    v_mul_f32 v71, v71, v241
    v_mul_f32 v84, v84, v241
    v_mul_f32 v85, v85, v241
    v_mul_f32 v86, v86, v241
    v_mul_f32 v87, v87, v241
    v_mul_f32 v100, v100, v241
    v_mul_f32 v101, v101, v241
    v_mul_f32 v102, v102, v241
    v_mul_f32 v103, v103, v241
    v_mul_f32 v116, v116, v241
    v_mul_f32 v117, v117, v241
    v_mul_f32 v118, v118, v241
    v_mul_f32 v119, v119, v241
    v_mul_f32 v132, v132, v241
    v_mul_f32 v133, v133, v241
    v_mul_f32 v134, v134, v241
    v_mul_f32 v135, v135, v241
    v_mul_f32 v148, v148, v241
    v_mul_f32 v149, v149, v241
    v_mul_f32 v150, v150, v241
    v_mul_f32 v151, v151, v241
    v_mul_f32 v164, v164, v241
    v_mul_f32 v165, v165, v241
    v_mul_f32 v166, v166, v241
    v_mul_f32 v167, v167, v241
    v_accvgpr_read_b32 v202, a4
    v_mul_f32 v202, v202, v241
    v_accvgpr_write_b32 a4, v202
    v_accvgpr_read_b32 v202, a5
    v_mul_f32 v202, v202, v241
    v_accvgpr_write_b32 a5, v202
    v_accvgpr_read_b32 v202, a6
    v_mul_f32 v202, v202, v241
    v_accvgpr_write_b32 a6, v202
    v_accvgpr_read_b32 v202, a7
    v_mul_f32 v202, v202, v241
    v_accvgpr_write_b32 a7, v202
    v_accvgpr_read_b32 v202, a20
    v_mul_f32 v202, v202, v241
    v_accvgpr_write_b32 a20, v202
    v_accvgpr_read_b32 v202, a21
    v_mul_f32 v202, v202, v241
    v_accvgpr_write_b32 a21, v202
    v_accvgpr_read_b32 v202, a22
    v_mul_f32 v202, v202, v241
    v_accvgpr_write_b32 a22, v202
    v_accvgpr_read_b32 v202, a23
    v_mul_f32 v202, v202, v241
    v_accvgpr_write_b32 a23, v202
    v_accvgpr_read_b32 v202, a36
    v_mul_f32 v202, v202, v241
    v_accvgpr_write_b32 a36, v202
    v_accvgpr_read_b32 v202, a37
    v_mul_f32 v202, v202, v241
    v_accvgpr_write_b32 a37, v202
    v_accvgpr_read_b32 v202, a38
    v_mul_f32 v202, v202, v241
    v_accvgpr_write_b32 a38, v202
    v_accvgpr_read_b32 v202, a39
    v_mul_f32 v202, v202, v241
    v_accvgpr_write_b32 a39, v202
    v_accvgpr_read_b32 v202, a52
    v_mul_f32 v202, v202, v241
    v_accvgpr_write_b32 a52, v202
    v_accvgpr_read_b32 v202, a53
    v_mul_f32 v202, v202, v241
    v_accvgpr_write_b32 a53, v202
    v_accvgpr_read_b32 v202, a54
    v_mul_f32 v202, v202, v241
    v_accvgpr_write_b32 a54, v202
    v_accvgpr_read_b32 v202, a55
    v_mul_f32 v202, v202, v241
    v_accvgpr_write_b32 a55, v202
    v_accvgpr_read_b32 v202, a68
    v_mul_f32 v202, v202, v241
    v_accvgpr_write_b32 a68, v202
    v_accvgpr_read_b32 v202, a69
    v_mul_f32 v202, v202, v241
    v_accvgpr_write_b32 a69, v202
    v_accvgpr_read_b32 v202, a70
    v_mul_f32 v202, v202, v241
    v_accvgpr_write_b32 a70, v202
    v_accvgpr_read_b32 v202, a71
    v_mul_f32 v202, v202, v241
    v_accvgpr_write_b32 a71, v202
    v_accvgpr_read_b32 v202, a240
    v_mul_f32 v202, v202, v241
    v_accvgpr_write_b32 a240, v202
    v_accvgpr_read_b32 v202, a241
    v_mul_f32 v202, v202, v241
    v_accvgpr_write_b32 a241, v202
    v_accvgpr_read_b32 v202, a242
    v_mul_f32 v202, v202, v241
    v_accvgpr_write_b32 a242, v202
    v_accvgpr_read_b32 v202, a243
    v_mul_f32 v202, v202, v241
    v_accvgpr_write_b32 a243, v202
    v_sub_f32 v242, 0, v206
    v_exp_f32 v242, v242
    s_nop 0
    v_sub_f32 v224, v224, v206
    v_mul_f32 v72, v72, v242
    v_mul_f32 v73, v73, v242
    v_mul_f32 v74, v74, v242
    v_mul_f32 v75, v75, v242
    v_mul_f32 v88, v88, v242
    v_mul_f32 v89, v89, v242
    v_mul_f32 v90, v90, v242
    v_mul_f32 v91, v91, v242
    v_mul_f32 v104, v104, v242
    v_mul_f32 v105, v105, v242
    v_mul_f32 v106, v106, v242
    v_mul_f32 v107, v107, v242
    v_mul_f32 v120, v120, v242
    v_mul_f32 v121, v121, v242
    v_mul_f32 v122, v122, v242
    v_mul_f32 v123, v123, v242
    v_mul_f32 v136, v136, v242
    v_mul_f32 v137, v137, v242
    v_mul_f32 v138, v138, v242
    v_mul_f32 v139, v139, v242
    v_mul_f32 v152, v152, v242
    v_mul_f32 v153, v153, v242
    v_mul_f32 v154, v154, v242
    v_mul_f32 v155, v155, v242
    v_mul_f32 v168, v168, v242
    v_mul_f32 v169, v169, v242
    v_mul_f32 v170, v170, v242
    v_mul_f32 v171, v171, v242
    v_accvgpr_read_b32 v202, a8
    v_mul_f32 v202, v202, v242
    v_accvgpr_write_b32 a8, v202
    v_accvgpr_read_b32 v202, a9
    v_mul_f32 v202, v202, v242
    v_accvgpr_write_b32 a9, v202
    v_accvgpr_read_b32 v202, a10
    v_mul_f32 v202, v202, v242
    v_accvgpr_write_b32 a10, v202
    v_accvgpr_read_b32 v202, a11
    v_mul_f32 v202, v202, v242
    v_accvgpr_write_b32 a11, v202
    v_accvgpr_read_b32 v202, a24
    v_mul_f32 v202, v202, v242
    v_accvgpr_write_b32 a24, v202
    v_accvgpr_read_b32 v202, a25
    v_mul_f32 v202, v202, v242
    v_accvgpr_write_b32 a25, v202
    v_accvgpr_read_b32 v202, a26
    v_mul_f32 v202, v202, v242
    v_accvgpr_write_b32 a26, v202
    v_accvgpr_read_b32 v202, a27
    v_mul_f32 v202, v202, v242
    v_accvgpr_write_b32 a27, v202
    v_accvgpr_read_b32 v202, a40
    v_mul_f32 v202, v202, v242
    v_accvgpr_write_b32 a40, v202
    v_accvgpr_read_b32 v202, a41
    v_mul_f32 v202, v202, v242
    v_accvgpr_write_b32 a41, v202
    v_accvgpr_read_b32 v202, a42
    v_mul_f32 v202, v202, v242
    v_accvgpr_write_b32 a42, v202
    v_accvgpr_read_b32 v202, a43
    v_mul_f32 v202, v202, v242
    v_accvgpr_write_b32 a43, v202
    v_accvgpr_read_b32 v202, a56
    v_mul_f32 v202, v202, v242
    v_accvgpr_write_b32 a56, v202
    v_accvgpr_read_b32 v202, a57
    v_mul_f32 v202, v202, v242
    v_accvgpr_write_b32 a57, v202
    v_accvgpr_read_b32 v202, a58
    v_mul_f32 v202, v202, v242
    v_accvgpr_write_b32 a58, v202
    v_accvgpr_read_b32 v202, a59
    v_mul_f32 v202, v202, v242
    v_accvgpr_write_b32 a59, v202
    v_accvgpr_read_b32 v202, a72
    v_mul_f32 v202, v202, v242
    v_accvgpr_write_b32 a72, v202
    v_accvgpr_read_b32 v202, a73
    v_mul_f32 v202, v202, v242
    v_accvgpr_write_b32 a73, v202
    v_accvgpr_read_b32 v202, a74
    v_mul_f32 v202, v202, v242
    v_accvgpr_write_b32 a74, v202
    v_accvgpr_read_b32 v202, a75
    v_mul_f32 v202, v202, v242
    v_accvgpr_write_b32 a75, v202
    v_accvgpr_read_b32 v202, a244
    v_mul_f32 v202, v202, v242
    v_accvgpr_write_b32 a244, v202
    v_accvgpr_read_b32 v202, a245
    v_mul_f32 v202, v202, v242
    v_accvgpr_write_b32 a245, v202
    v_accvgpr_read_b32 v202, a246
    v_mul_f32 v202, v202, v242
    v_accvgpr_write_b32 a246, v202
    v_accvgpr_read_b32 v202, a247
    v_mul_f32 v202, v202, v242
    v_accvgpr_write_b32 a247, v202
    v_sub_f32 v243, 0, v207
    v_exp_f32 v243, v243
    s_nop 0
    v_sub_f32 v225, v225, v207
    v_mul_f32 v76, v76, v243
    v_mul_f32 v77, v77, v243
    v_mul_f32 v78, v78, v243
    v_mul_f32 v79, v79, v243
    v_mul_f32 v92, v92, v243
    v_mul_f32 v93, v93, v243
    v_mul_f32 v94, v94, v243
    v_mul_f32 v95, v95, v243
    v_mul_f32 v108, v108, v243
    v_mul_f32 v109, v109, v243
    v_mul_f32 v110, v110, v243
    v_mul_f32 v111, v111, v243
    v_mul_f32 v124, v124, v243
    v_mul_f32 v125, v125, v243
    v_mul_f32 v126, v126, v243
    v_mul_f32 v127, v127, v243
    v_mul_f32 v140, v140, v243
    v_mul_f32 v141, v141, v243
    v_mul_f32 v142, v142, v243
    v_mul_f32 v143, v143, v243
    v_mul_f32 v156, v156, v243
    v_mul_f32 v157, v157, v243
    v_mul_f32 v158, v158, v243
    v_mul_f32 v159, v159, v243
    v_mul_f32 v172, v172, v243
    v_mul_f32 v173, v173, v243
    v_mul_f32 v174, v174, v243
    v_mul_f32 v175, v175, v243
    v_accvgpr_read_b32 v202, a12
    v_mul_f32 v202, v202, v243
    v_accvgpr_write_b32 a12, v202
    v_accvgpr_read_b32 v202, a13
    v_mul_f32 v202, v202, v243
    v_accvgpr_write_b32 a13, v202
    v_accvgpr_read_b32 v202, a14
    v_mul_f32 v202, v202, v243
    v_accvgpr_write_b32 a14, v202
    v_accvgpr_read_b32 v202, a15
    v_mul_f32 v202, v202, v243
    v_accvgpr_write_b32 a15, v202
    v_accvgpr_read_b32 v202, a28
    v_mul_f32 v202, v202, v243
    v_accvgpr_write_b32 a28, v202
    v_accvgpr_read_b32 v202, a29
    v_mul_f32 v202, v202, v243
    v_accvgpr_write_b32 a29, v202
    v_accvgpr_read_b32 v202, a30
    v_mul_f32 v202, v202, v243
    v_accvgpr_write_b32 a30, v202
    v_accvgpr_read_b32 v202, a31
    v_mul_f32 v202, v202, v243
    v_accvgpr_write_b32 a31, v202
    v_accvgpr_read_b32 v202, a44
    v_mul_f32 v202, v202, v243
    v_accvgpr_write_b32 a44, v202
    v_accvgpr_read_b32 v202, a45
    v_mul_f32 v202, v202, v243
    v_accvgpr_write_b32 a45, v202
    v_accvgpr_read_b32 v202, a46
    v_mul_f32 v202, v202, v243
    v_accvgpr_write_b32 a46, v202
    v_accvgpr_read_b32 v202, a47
    v_mul_f32 v202, v202, v243
    v_accvgpr_write_b32 a47, v202
    v_accvgpr_read_b32 v202, a60
    v_mul_f32 v202, v202, v243
    v_accvgpr_write_b32 a60, v202
    v_accvgpr_read_b32 v202, a61
    v_mul_f32 v202, v202, v243
    v_accvgpr_write_b32 a61, v202
    v_accvgpr_read_b32 v202, a62
    v_mul_f32 v202, v202, v243
    v_accvgpr_write_b32 a62, v202
    v_accvgpr_read_b32 v202, a63
    v_mul_f32 v202, v202, v243
    v_accvgpr_write_b32 a63, v202
    v_accvgpr_read_b32 v202, a76
    v_mul_f32 v202, v202, v243
    v_accvgpr_write_b32 a76, v202
    v_accvgpr_read_b32 v202, a77
    v_mul_f32 v202, v202, v243
    v_accvgpr_write_b32 a77, v202
    v_accvgpr_read_b32 v202, a78
    v_mul_f32 v202, v202, v243
    v_accvgpr_write_b32 a78, v202
    v_accvgpr_read_b32 v202, a79
    v_mul_f32 v202, v202, v243
    v_accvgpr_write_b32 a79, v202
    v_accvgpr_read_b32 v202, a248
    v_mul_f32 v202, v202, v243
    v_accvgpr_write_b32 a248, v202
    v_accvgpr_read_b32 v202, a249
    v_mul_f32 v202, v202, v243
    v_accvgpr_write_b32 a249, v202
    v_accvgpr_read_b32 v202, a250
    v_mul_f32 v202, v202, v243
    v_accvgpr_write_b32 a250, v202
    v_accvgpr_read_b32 v202, a251
    v_mul_f32 v202, v202, v243
    v_accvgpr_write_b32 a251, v202
    v_sub_f32 v32, v32, v204
    v_sub_f32 v33, v33, v204
    v_sub_f32 v34, v34, v204
    v_sub_f32 v35, v35, v204
    v_sub_f32 v48, v48, v204
    v_sub_f32 v49, v49, v204
    v_sub_f32 v50, v50, v204
    v_sub_f32 v51, v51, v204
    v_exp_f32 v202, v32
    v_exp_f32 v203, v33
    s_nop 0
    v_cvt_pk_bf16_f32 v180, v202, v203
    v_exp_f32 v202, v34
    v_exp_f32 v203, v35
    s_nop 0
    v_cvt_pk_bf16_f32 v181, v202, v203
    v_exp_f32 v202, v48
    v_exp_f32 v203, v49
    s_nop 0
    v_cvt_pk_bf16_f32 v182, v202, v203
    v_exp_f32 v202, v50
    v_exp_f32 v203, v51
    s_nop 0
    v_cvt_pk_bf16_f32 v183, v202, v203
    v_sub_f32 v36, v36, v205
    v_sub_f32 v37, v37, v205
    v_sub_f32 v38, v38, v205
    v_sub_f32 v39, v39, v205
    v_sub_f32 v52, v52, v205
    v_sub_f32 v53, v53, v205
    v_sub_f32 v54, v54, v205
    v_sub_f32 v55, v55, v205
    v_exp_f32 v202, v36
    v_exp_f32 v203, v37
    s_nop 0
    v_cvt_pk_bf16_f32 v188, v202, v203
    v_exp_f32 v202, v38
    v_exp_f32 v203, v39
    s_nop 0
    v_cvt_pk_bf16_f32 v189, v202, v203
    v_exp_f32 v202, v52
    v_exp_f32 v203, v53
    s_nop 0
    v_cvt_pk_bf16_f32 v190, v202, v203
    v_exp_f32 v202, v54
    v_exp_f32 v203, v55
    s_nop 0
    v_cvt_pk_bf16_f32 v191, v202, v203
    v_sub_f32 v40, v40, v206
    v_sub_f32 v41, v41, v206
    v_sub_f32 v42, v42, v206
    v_sub_f32 v43, v43, v206
    v_sub_f32 v56, v56, v206
    v_sub_f32 v57, v57, v206
    v_sub_f32 v58, v58, v206
    v_sub_f32 v59, v59, v206
    v_exp_f32 v202, v40
    v_exp_f32 v203, v41
    s_nop 0
    v_cvt_pk_bf16_f32 v192, v202, v203
    v_exp_f32 v202, v42
    v_exp_f32 v203, v43
    s_nop 0
    v_cvt_pk_bf16_f32 v193, v202, v203
    v_exp_f32 v202, v56
    v_exp_f32 v203, v57
    s_nop 0
    v_cvt_pk_bf16_f32 v194, v202, v203
    v_exp_f32 v202, v58
    v_exp_f32 v203, v59
    s_nop 0
    v_cvt_pk_bf16_f32 v195, v202, v203
    v_sub_f32 v44, v44, v207
    v_sub_f32 v45, v45, v207
    v_sub_f32 v46, v46, v207
    v_sub_f32 v47, v47, v207
    v_sub_f32 v60, v60, v207
    v_sub_f32 v61, v61, v207
    v_sub_f32 v62, v62, v207
    v_sub_f32 v63, v63, v207
    v_exp_f32 v202, v44
    v_exp_f32 v203, v45
    s_nop 0
    v_cvt_pk_bf16_f32 v196, v202, v203
    v_exp_f32 v202, v46
    v_exp_f32 v203, v47
    s_nop 0
    v_cvt_pk_bf16_f32 v197, v202, v203
    v_exp_f32 v202, v60
    v_exp_f32 v203, v61
    s_nop 0
    v_cvt_pk_bf16_f32 v198, v202, v203
    v_exp_f32 v202, v62
    v_exp_f32 v203, v63
    s_nop 0
    v_cvt_pk_bf16_f32 v199, v202, v203
    s_nop 1
    s_cmp_eq_u32 s30, 0
    s_cbranch_scc1 L_ret_b0o
    s_cmp_eq_u32 s30, 7
    s_cbranch_scc1 L_ret_b7o
    s_cmp_eq_u32 s30, 8
    s_cbranch_scc1 L_ret_blo
    s_branch L_ret_sto

.section .rodata,"a"
.p2align 6
.amdhsa_kernel standalone__gqa_softmax__near_ridge_kernel
  .amdhsa_next_free_vgpr 512
  .amdhsa_next_free_sgpr 80
  .amdhsa_accum_offset 256
  .amdhsa_group_segment_fixed_size 0
  .amdhsa_kernarg_size 48
  .amdhsa_user_sgpr_count 2
  .amdhsa_user_sgpr_kernarg_segment_ptr 1
  .amdhsa_system_sgpr_workgroup_id_x 1
  .amdhsa_float_denorm_mode_32 3
.end_amdhsa_kernel
```
